```python
import torch

def _softmax(x, axis=-1):
    return torch.softmax(x, dim=axis)

def _gelu(x):
    return torch.nn.functional.gelu(x, approximate='tanh')

def _silu(x):
    return torch.nn.functional.silu(x)

def _sigmoid(x):
    return torch.sigmoid(x)

def _layernorm(x, axis=-1, eps=1e-05):
    m = x.mean(dim=axis, keepdim=True)
    v = x.var(dim=axis, keepdim=True, unbiased=False)
    return (x - m) / torch.sqrt(v + eps)

def _scatter_add(tgt, idx, src, axis=0):
    return tgt.clone().index_add_(axis, idx, src)

def _segment_sum(src, seg, n):
    out = torch.zeros((n,) + src.shape[1:], dtype=src.dtype)
    return out.index_add_(0, seg, src)

def _pad(x, pw):
    flat = tuple((v for pair in reversed(pw) for v in pair))
    return torch.nn.functional.pad(x, flat)
kernel_name = 'standalone__kv_cache_quant_pre_rope_vs_post_rope__prompt'

def setup_inputs():

    _w = lambda a: (lambda t: t.to(torch.bfloat16) if t.is_floating_point() else t)(torch.as_tensor(a))
    B, Sq, Skv = (1, 2048, 2048)
    H, Dh0 = (4, 128)
    G = 128 if 128 > 0 else Dh0
    G = max(2, G // 2 * 2)
    Dh = max(G, Dh0 // G * G)
    Skv = max(Skv, Sq)
    ng = Dh // G
    bits = 2 if 2 > 1 else 4
    bits = max(2, min(8, bits))
    qmax = (1 << bits) - 1
    half = Dh // 2
    inv = 1.0 / 10000.0 ** (torch.arange(half) / max(1, half))
    ang_k = torch.arange(Skv)[:, None] * inv[None, :]
    ang_q = torch.arange(Skv - Sq, Skv)[:, None] * inv[None, :]
    kc = torch.cat([torch.cos(ang_k), torch.cos(ang_k)], dim=-1)
    ks = torch.cat([torch.sin(ang_k), torch.sin(ang_k)], dim=-1)
    qc = torch.cat([torch.cos(ang_q), torch.cos(ang_q)], dim=-1)
    qs = torch.cat([torch.sin(ang_q), torch.sin(ang_q)], dim=-1)
    qk_i = torch.randint(0, qmax + 1, (B, H, Skv, Dh)).to(torch.int32)
    qv_i = torch.randint(0, qmax + 1, (B, H, Skv, Dh)).to(torch.int32)
    ksc = torch.abs((lambda *s: torch.randn(*s, dtype=torch.bfloat16) * 0.4)(B, H, Skv, ng)) * 0.1 + 0.01
    kzp = torch.full((B, H, Skv, ng), qmax / 2.0)
    vsc = torch.abs((lambda *s: torch.randn(*s, dtype=torch.bfloat16) * 0.4)(B, H, Skv, ng)) * 0.1 + 0.01
    vzp = torch.full((B, H, Skv, ng), qmax / 2.0)
    return {'q': _w((lambda *s: torch.randn(*s, dtype=torch.bfloat16) * 6.4)(B, H, Sq, Dh) * 0.5), 'qk': _w(qk_i), 'k_scales': _w(ksc), 'k_zeros': _w(kzp), 'qv': _w(qv_i), 'v_scales': _w(vsc), 'v_zeros': _w(vzp), 'q_cos': _w(qc), 'q_sin': _w(qs), 'k_cos': _w(kc), 'k_sin': _w(ks)}

def reference(q, qk, k_scales, k_zeros, qv, v_scales, v_zeros, q_cos, q_sin, k_cos, k_sin):
    B, H, Sq, Dh = q.shape
    ng = k_scales.shape[-1]
    G = Dh // ng
    half = Dh // 2
    ks = (lambda x, n, axis: torch.repeat_interleave(x, n, dim=axis))(k_scales, G, axis=-1)
    kz = (lambda x, n, axis: torch.repeat_interleave(x, n, dim=axis))(k_zeros, G, axis=-1)
    k = ((lambda x, dt: x.to(dt))(qk, q.dtype) - kz) * ks
    vs = (lambda x, n, axis: torch.repeat_interleave(x, n, dim=axis))(v_scales, G, axis=-1)
    vz = (lambda x, n, axis: torch.repeat_interleave(x, n, dim=axis))(v_zeros, G, axis=-1)
    v = ((lambda x, dt: x.to(dt))(qv, q.dtype) - vz) * vs
    k1 = k[..., :half].clone()
    k2 = k[..., half:].clone()
    krh = torch.concatenate([-k2, k1], axis=-1)
    kr = k * k_cos[None, None, :, :] + krh * k_sin[None, None, :, :]
    q1 = q[..., :half].clone()
    q2 = q[..., half:].clone()
    qrh = torch.concatenate([-q2, q1], axis=-1)
    qr = q * q_cos[None, None, :, :] + qrh * q_sin[None, None, :, :]
    logits = torch.einsum('bhqd,bhkd->bhqk', qr, kr) * float(Dh) ** (-0.5)
    attn = _softmax(logits, axis=-1)
    out = torch.einsum('bhqk,bhkd->bhqd', attn, v)
    return out
```

```asm
; @launch grid=(256,1,1) block=(256,1,1) lds=114688
.amdgcn_target "amdgcn-amd-amdhsa--gfx950"
.text
.p2align 12
.fill 384, 4, 0xBF800000
.text
.globl standalone__kv_cache_quant_pre_rope_vs_post_rope__prompt_kernel
.p2align 8
.type standalone__kv_cache_quant_pre_rope_vs_post_rope__prompt_kernel,@function
standalone__kv_cache_quant_pre_rope_vs_post_rope__prompt_kernel:
  s_load_dwordx16 s[4:19], s[0:1], 0
  s_getpc_b64 s[60:61]
  v_lshlrev_b32 v64, 5, v0

  global_load_dword v255, v64, s[60:61]
  s_cmpk_ge_u32 s2, 256
  s_cbranch_scc1 L_end
  s_and_b32 s52, s2, 7
  s_lshr_b32 s35, s2, 3
  s_lshl_b32 s57, s52, 5
  s_or_b32 s57, s57, s35
  s_lshl_b32 s53, s57, 14
  v_and_b32 v25, 7, v0
  v_lshrrev_b32 v26, 3, v0
  v_lshl_add_u32 v29, v25, 4, s53
  v_lshl_add_u32 v28, v26, 9, v29

  s_waitcnt lgkmcnt(0)
  global_load_dwordx4 v[32:35], v28, s[6:7] offset:0
  global_load_dwordx4 v[36:39], v28, s[6:7] offset:128
  global_load_dwordx4 v[40:43], v28, s[6:7] offset:256
  global_load_dwordx4 v[44:47], v28, s[6:7] offset:384
  s_load_dwordx2 s[22:23], s[0:1], 104
  s_load_dwordx2 s[20:21], s[0:1], 88
  s_lshl_b32 s53, s57, 6
  v_lshl_add_u32 v27, v26, 1, s53
  global_load_ushort v30, v27, s[8:9]
  global_load_ushort v31, v27, s[10:11]
  s_and_b32 s3, s53, 0x3000
  v_lshl_add_u32 v70, v0, 4, s3
  global_load_dwordx4 v[88:91], v70, s[14:15]
  global_load_dwordx4 v[92:95], v70, s[16:17]
  s_and_b32 s3, s57, 1
  s_mul_i32 s3, s3, -16128
  v_bfe_u32 v64, v0, 4, 2
  v_lshl_add_u32 v29, v64, 12, v29
  v_bfe_u32 v64, v0, 3, 1
  v_lshl_add_u32 v29, v64, 14, v29
  v_bfe_u32 v64, v0, 6, 1
  v_lshl_add_u32 v29, v64, 11, v29
  v_and_b32 v64, 128, v0
  v_add3_u32 v29, v29, v64, s3

  global_load_dwordx4 v[48:51], v29, s[12:13] offset:0
  global_load_dwordx4 v[52:55], v29, s[12:13] offset:512
  global_load_dwordx4 v[56:59], v29, s[12:13] offset:1024
  global_load_dwordx4 v[60:63], v29, s[12:13] offset:1536
  v_lshrrev_b32 v1, 6, v0
  v_and_b32 v24, 7, v26
  v_readfirstlane_b32 s32, v1
  v_and_b32 v2, 63, v0
  s_lshr_b32 s33, s52, 1
  s_lshl_b32 s53, s33, 7
  s_waitcnt lgkmcnt(0)
  s_load_dword s39, s[22:23], s53
  s_and_b32 s34, s52, 1
  s_lshl_b32 s59, s52, 8
  s_add_u32 s59, s59, 4096
  s_and_b32 s36, s35, 1
  s_mov_b32 s24, s22
  s_and_b32 s25, s23, 0xffff
  s_mov_b32 s26, 0x10000000
  s_mov_b32 s27, 0x20000
  s_mul_i32 s37, s57, 10240
  s_add_u32 s37, s37, 4194304
  s_lshl_b32 s54, s2, 2
  s_add_u32 s54, s54, s32
  s_lshl_b32 s54, s54, 13
  s_add_u32 s54, s54, 8388608

  buffer_load_dword v254, off, s[24:27], s59
  v_bfe_u32 v150, v27, 1, 11
  v_cvt_f32_u32 v144, v25
  v_mul_f32 v144, 0xbf549a78, v144
  v_exp_f32 v144, v144
  v_cvt_f32_u32 v145, v150
  v_mul_f32 v144, v144, v145

  v_mul_f32 v104, 0x3e22f983, v144
  v_cos_f32 v146, v104
  v_mul_f32 v105, 0x3e0d2158, v144
  v_sin_f32 v147, v104
  v_cos_f32 v148, v105
  v_mul_f32 v106, 0x3df46d71, v144
  v_cvt_pk_bf16_f32 v96, v146, v147
  v_sin_f32 v149, v105
  v_cvt_pk_bf16_f32 v104, v147, v146
  v_cos_f32 v146, v106
  v_mul_f32 v107, 0x3dd3aa5e, v144
  v_cvt_pk_bf16_f32 v97, v148, v149
  v_sin_f32 v147, v106
  v_cvt_pk_bf16_f32 v105, v149, v148
  v_cos_f32 v148, v107
  v_mul_f32 v108, 0x3ad09b8a, v144
  v_cvt_pk_bf16_f32 v98, v146, v147
  v_sin_f32 v149, v107
  v_cvt_pk_bf16_f32 v106, v147, v146
  v_cos_f32 v146, v108
  v_mul_f32 v109, 0x3ab4a58f, v144
  v_cvt_pk_bf16_f32 v99, v148, v149
  v_sin_f32 v147, v108
  v_cvt_pk_bf16_f32 v107, v149, v148
  v_cos_f32 v148, v109
  v_mul_f32 v110, 0x3a9c6f01, v144
  v_cvt_pk_bf16_f32 v100, v146, v147
  v_sin_f32 v149, v109
  v_cvt_pk_bf16_f32 v108, v147, v146
  v_cos_f32 v146, v110
  v_mul_f32 v111, 0x3a877747, v144
  v_cvt_pk_bf16_f32 v101, v148, v149
  v_sin_f32 v147, v110
  v_cvt_pk_bf16_f32 v109, v149, v148
  v_cos_f32 v148, v111
  v_cvt_pk_bf16_f32 v102, v146, v147
  v_sin_f32 v149, v111
  v_cvt_pk_bf16_f32 v110, v147, v146
  v_cvt_pk_bf16_f32 v103, v148, v149
  v_cvt_pk_bf16_f32 v111, v149, v148
  v_mul_u32_u24 v173, 144, v26
  v_lshl_add_u32 v173, v25, 4, v173
  v_lshl_add_u32 v174, v1, 3, v25
  v_mul_u32_u24 v172, 144, v174
  v_lshl_add_u32 v172, v24, 4, v172
  v_lshlrev_b32 v174, 4, v174
  v_lshl_add_u32 v174, v24, 9, v174
  v_add_u32 v175, 0x1000, v174
  v_lshrrev_b32 v176, 4, v0
  v_xor_b32 v177, v176, v0
  v_lshl_add_u32 v176, v176, 3, v25
  v_bfe_u32 v177, v177, 3, 1
  v_lshlrev_b32 v176, 4, v176
  v_lshl_add_u32 v176, v177, 29, v176
  v_add_u32 v176, 0x2000, v176
  v_bfe_i32 v177, v0, 4, 1
  v_and_b32 v177, 0x02020202, v177
  v_or_b32 v177, 0x05040100, v177
  v_mov_b32 v178, 0x11111111

  v_min_u32 v64, 3, v2
  v_lshl_add_u32 v64, v64, 2, v1
  s_and_b32 s53, s35, 7
  s_add_u32 s53, s53, 64
  v_lshl_add_u32 v64, v64, 3, s53
  v_lshlrev_b32 v64, 7, v64

  global_load_dword v255, v64, s[60:61]
  s_lshr_b32 s52, s32, 1
  s_xor_b32 s53, s57, s52
  s_lshl_b32 s53, s53, 5
  v_bfe_u32 v66, v0, 2, 5
  v_and_b32 v71, 3, v0
  v_add_u32 v67, s53, v66
  v_lshlrev_b32 v68, 8, v67
  v_lshl_add_u32 v68, v71, 4, v68
  v_and_b32 v67, 2047, v67
  s_mul_i32 s52, s52, 8448
  v_mul_u32_u24 v180, 1056, v71
  v_lshl_add_u32 v180, v66, 4, v180
  v_add_u32 v180, s52, v180

  v_cvt_f32_u32 v144, v71
  v_mul_f32 v144, 0xbfd49a78, v144
  v_exp_f32 v144, v144
  v_cvt_f32_u32 v145, v67
  v_mul_f32 v144, v144, v145

  v_mul_f32 v128, 0x3e22f983, v144
  v_cos_f32 v146, v128
  v_mul_f32 v129, 0x3e0d2158, v144
  v_sin_f32 v147, v128
  v_cos_f32 v148, v129
  v_mul_f32 v130, 0x3df46d71, v144
  v_cvt_pk_bf16_f32 v112, v146, v147
  v_sin_f32 v149, v129
  v_cvt_pk_bf16_f32 v128, v147, v146
  v_cos_f32 v146, v130
  v_mul_f32 v131, 0x3dd3aa5e, v144
  v_cvt_pk_bf16_f32 v113, v148, v149
  v_sin_f32 v147, v130
  v_cvt_pk_bf16_f32 v129, v149, v148
  v_cos_f32 v148, v131
  v_mul_f32 v132, 0x3db74b76, v144
  v_cvt_pk_bf16_f32 v114, v146, v147
  v_sin_f32 v149, v131
  v_cvt_pk_bf16_f32 v130, v147, v146
  v_cos_f32 v146, v132
  v_mul_f32 v133, 0x3d9eba0b, v144
  v_cvt_pk_bf16_f32 v115, v148, v149
  v_sin_f32 v147, v132
  v_cvt_pk_bf16_f32 v131, v149, v148
  v_cos_f32 v148, v133
  v_mul_f32 v134, 0x3d8973a2, v144
  v_cvt_pk_bf16_f32 v116, v146, v147
  v_sin_f32 v149, v133
  v_cvt_pk_bf16_f32 v132, v147, v146
  v_cos_f32 v146, v134
  v_mul_f32 v135, 0x3d6e0e78, v144
  v_cvt_pk_bf16_f32 v117, v148, v149
  v_sin_f32 v147, v134
  v_cvt_pk_bf16_f32 v133, v149, v148
  v_cos_f32 v148, v135
  v_mul_f32 v136, 0x3ad09b8a, v144
  v_cvt_pk_bf16_f32 v118, v146, v147
  v_sin_f32 v149, v135
  v_cvt_pk_bf16_f32 v134, v147, v146
  v_cos_f32 v146, v136
  v_mul_f32 v137, 0x3ab4a58f, v144
  v_cvt_pk_bf16_f32 v119, v148, v149
  v_sin_f32 v147, v136
  v_cvt_pk_bf16_f32 v135, v149, v148
  v_cos_f32 v148, v137
  v_mul_f32 v138, 0x3a9c6f01, v144
  v_cvt_pk_bf16_f32 v120, v146, v147
  v_sin_f32 v149, v137
  v_cvt_pk_bf16_f32 v136, v147, v146
  v_cos_f32 v146, v138
  v_mul_f32 v139, 0x3a877747, v144
  v_cvt_pk_bf16_f32 v121, v148, v149
  v_sin_f32 v147, v138
  v_cvt_pk_bf16_f32 v137, v149, v148
  v_cos_f32 v148, v139
  v_mul_f32 v140, 0x3a6a9e08, v144
  v_cvt_pk_bf16_f32 v122, v146, v147
  v_sin_f32 v149, v139
  v_cvt_pk_bf16_f32 v138, v147, v146
  v_cos_f32 v146, v140
  v_mul_f32 v141, 0x3a4b2b94, v144
  v_cvt_pk_bf16_f32 v123, v148, v149
  v_sin_f32 v147, v140
  v_cvt_pk_bf16_f32 v139, v149, v148
  v_cos_f32 v148, v141
  v_mul_f32 v142, 0x3a2ff02b, v144
  v_cvt_pk_bf16_f32 v124, v146, v147
  v_sin_f32 v149, v141
  v_cvt_pk_bf16_f32 v140, v147, v146
  v_cos_f32 v146, v142
  v_mul_f32 v143, 0x3a185b2e, v144
  v_cvt_pk_bf16_f32 v125, v148, v149
  v_sin_f32 v147, v142
  v_cvt_pk_bf16_f32 v141, v149, v148
  v_cos_f32 v148, v143
  v_cvt_pk_bf16_f32 v126, v146, v147
  v_sin_f32 v149, v143
  v_cvt_pk_bf16_f32 v142, v147, v146
  v_cvt_pk_bf16_f32 v127, v148, v149
  v_cvt_pk_bf16_f32 v143, v149, v148
  s_lshl_b32 s52, s34, 3
  s_lshl_b32 s53, s36, 2
  s_add_u32 s18, s52, s53
  s_xor_b32 s52, s52, 8
  s_mul_i32 s53, s36, 2
  s_add_u32 s19, s52, s53
  s_add_u32 s3, s52, 4
  v_lshlrev_b32 v179, 5, v0
  v_lshrrev_b32 v171, 1, v0
  v_mul_u32_u24 v171, 96, v171
  v_and_b32 v170, 1, v0
  v_lshl_add_u32 v171, v170, 3, v171
  v_add_u32 v171, 36352, v171
  v_bfe_u32 v157, v0, 4, 1
  v_bfe_u32 v158, v0, 1, 3
  v_cmp_eq_u32 vcc, v157, v158
  v_bfe_u32 v157, v0, 5, 3
  v_and_b32 v158, 1, v157
  v_cndmask_b32 v170, 2, v170, vcc
  v_mul_u32_u24 v158, 48, v158
  v_lshl_add_u32 v158, v170, 4, v158
  v_mul_u32_u24 v157, 192, v1
  v_add_u32 v158, v158, v157
  s_mul_i32 s52, s18, 768
  v_add_u32 v21, s52, v158
  s_mul_i32 s52, s19, 768
  v_add_u32 v252, s52, v158
  s_mul_i32 s52, s3, 768
  v_add_u32 v253, s52, v158
  v_lshrrev_b32 v151, 5, v2
  v_lshlrev_b32 v152, 4, v151
  v_lshl_add_u32 v152, v1, 7, v152
  s_lshl_b32 s52, s18, 9
  v_add_u32 v13, s52, v152
  s_lshl_b32 s52, s19, 9
  v_add_u32 v18, s52, v152
  v_cmp_eq_u32 vcc, 0, v0
  s_lshl_b32 s52, s33, 4

  s_add_u32 s53, s52, s18
  s_mul_i32 s53, s53, 40960
  s_add_u32 s42, s53, 4194304
  s_add_u32 s43, s53, 4235264
  s_add_u32 s44, s53, 4276224
  s_add_u32 s45, s53, 4317184
  s_add_u32 s53, s52, s19
  s_mul_i32 s53, s53, 40960
  s_add_u32 s46, s53, 4194304
  s_add_u32 s47, s53, 4235264
  s_add_u32 s53, s52, s3
  s_mul_i32 s53, s53, 40960
  s_add_u32 s48, s53, 4194304
  s_add_u32 s49, s53, 4235264
  s_add_u32 s50, s53, 4276224
  s_add_u32 s51, s53, 4317184
  v_bfrev_b32 v153, 4
  v_cndmask_b32 v19, v153, 0, vcc
  v_and_b32 v154, 31, v2
  v_lshlrev_b32 v237, 2, v154

  v_lshlrev_b32 v17, 4, v2
  v_lshl_add_u32 v23, v151, 4, v17
  s_mul_i32 s52, s32, 10240
  v_add_u32 v3, s52, v17
  v_add_u32 v4, 0x1000, v3
  s_getreg_b32 s41, hwreg(HW_REG_XCC_ID, 0, 4)

  global_load_dwordx4 v[72:75], v68, s[4:5] offset:0
  global_load_dwordx4 v[76:79], v68, s[4:5] offset:64
  global_load_dwordx4 v[80:83], v68, s[4:5] offset:128
  global_load_dwordx4 v[84:87], v68, s[4:5] offset:192
  s_waitcnt vmcnt(12)
  v_lshlrev_b32 v30, 16, v30
  v_lshlrev_b32 v31, 16, v31
  v_mul_f32 v30, 0x3e0293ee, v30
  v_mul_f32 v31, v31, v30
  v_cvt_f32_i32 v32, v32
  v_cvt_f32_i32 v33, v33
  v_cvt_f32_i32 v34, v34
  v_cvt_f32_i32 v35, v35
  v_cvt_f32_i32 v36, v36
  v_cvt_f32_i32 v37, v37
  v_cvt_f32_i32 v38, v38
  v_cvt_f32_i32 v39, v39
  v_cvt_f32_i32 v40, v40
  v_cvt_f32_i32 v41, v41
  v_cvt_f32_i32 v42, v42
  v_cvt_f32_i32 v43, v43
  v_cvt_f32_i32 v44, v44
  v_cvt_f32_i32 v45, v45
  v_cvt_f32_i32 v46, v46
  v_cvt_f32_i32 v47, v47
  v_fma_f32 v32, v32, v30, -v31
  v_fma_f32 v33, v33, v30, -v31
  v_fma_f32 v34, v34, v30, -v31
  v_fma_f32 v35, v35, v30, -v31
  v_fma_f32 v36, v36, v30, -v31
  v_fma_f32 v37, v37, v30, -v31
  v_fma_f32 v38, v38, v30, -v31
  v_fma_f32 v39, v39, v30, -v31
  v_fma_f32 v40, v40, v30, -v31
  v_fma_f32 v41, v41, v30, -v31
  v_fma_f32 v42, v42, v30, -v31
  v_fma_f32 v43, v43, v30, -v31
  v_fma_f32 v44, v44, v30, -v31
  v_fma_f32 v45, v45, v30, -v31
  v_fma_f32 v46, v46, v30, -v31
  v_fma_f32 v47, v47, v30, -v31
  v_cvt_pk_bf16_f32 v32, v32, v40
  v_cvt_pk_bf16_f32 v33, v33, v41
  v_cvt_pk_bf16_f32 v34, v34, v42
  v_cvt_pk_bf16_f32 v35, v35, v43
  v_cvt_pk_bf16_f32 v36, v36, v44
  v_cvt_pk_bf16_f32 v37, v37, v45
  v_cvt_pk_bf16_f32 v38, v38, v46
  v_cvt_pk_bf16_f32 v39, v39, v47
  v_dot2_f32_bf16 v96, v32, v96, 0 neg_hi:[0,1,0]
  v_dot2_f32_bf16 v97, v33, v97, 0 neg_hi:[0,1,0]
  v_dot2_f32_bf16 v98, v34, v98, 0 neg_hi:[0,1,0]
  v_dot2_f32_bf16 v99, v35, v99, 0 neg_hi:[0,1,0]
  v_dot2_f32_bf16 v100, v36, v100, 0 neg_hi:[0,1,0]
  v_dot2_f32_bf16 v101, v37, v101, 0 neg_hi:[0,1,0]
  v_dot2_f32_bf16 v102, v38, v102, 0 neg_hi:[0,1,0]
  v_dot2_f32_bf16 v103, v39, v103, 0 neg_hi:[0,1,0]
  v_dot2_f32_bf16 v104, v32, v104, 0
  v_dot2_f32_bf16 v105, v33, v105, 0
  v_dot2_f32_bf16 v106, v34, v106, 0
  v_dot2_f32_bf16 v107, v35, v107, 0
  v_dot2_f32_bf16 v108, v36, v108, 0
  v_dot2_f32_bf16 v109, v37, v109, 0
  v_dot2_f32_bf16 v110, v38, v110, 0
  v_dot2_f32_bf16 v111, v39, v111, 0
  v_cvt_pk_bf16_f32 v40, v96, v97
  v_cvt_pk_bf16_f32 v41, v98, v99
  v_cvt_pk_bf16_f32 v42, v100, v101
  v_cvt_pk_bf16_f32 v43, v102, v103
  s_waitcnt lgkmcnt(0)
  ds_write_b128 v172, v[40:43]
  v_cvt_pk_bf16_f32 v44, v104, v105
  v_cvt_pk_bf16_f32 v45, v106, v107
  v_cvt_pk_bf16_f32 v46, v108, v109
  v_cvt_pk_bf16_f32 v47, v110, v111
  ds_write_b128 v172, v[44:47] offset:4608
  ds_read_b128 v[160:163], v173
  ds_read_b128 v[164:167], v173 offset:4608
  s_waitcnt vmcnt(6)
  v_lshl_or_b32 v48, v52, 4, v48
  v_lshl_or_b32 v49, v53, 4, v49
  v_lshl_or_b32 v50, v54, 4, v50
  v_lshl_or_b32 v51, v55, 4, v51
  v_lshl_or_b32 v56, v60, 4, v56
  v_lshl_or_b32 v57, v61, 4, v57
  v_lshl_or_b32 v58, v62, 4, v58
  v_lshl_or_b32 v59, v63, 4, v59
  v_lshl_or_b32 v48, v56, 8, v48
  v_lshl_or_b32 v49, v57, 8, v49
  v_lshl_or_b32 v50, v58, 8, v50
  v_lshl_or_b32 v51, v59, 8, v51
  v_lshl_or_b32 v48, v49, 16, v48
  v_lshl_or_b32 v49, v51, 16, v50
  s_mov_b32 s52, 0x22222222
  s_mov_b32 s53, 0x88888888
  v_permlane32_swap_b32 v48, v49
  v_mov_b32 v50, v48
  v_mov_b32 v51, v49
  s_waitcnt lgkmcnt(0)
  buffer_store_dwordx4 v[160:163], v174, s[24:27], s37 offen sc1
  buffer_store_dwordx4 v[164:167], v175, s[24:27], s37 offen sc1
  v_permlane16_swap_b32 v48, v50
  v_permlane16_swap_b32 v49, v51
  v_perm_b32 v144, v50, v48, v177
  v_perm_b32 v145, v51, v49, v177
  v_lshlrev_b32 v55, 1, v144
  v_lshlrev_b32 v56, 2, v144
  v_bitop3_b32 v55, v144, v55, s52 bitop3:0x82
  v_bitop3_b32 v56, v56, s53, v178 bitop3:0xae
  v_or_b32 v144, v55, v56
  v_lshlrev_b32 v55, 1, v145
  v_lshlrev_b32 v56, 2, v145
  v_bitop3_b32 v55, v145, v55, s52 bitop3:0x82
  v_bitop3_b32 v56, v56, s53, v178 bitop3:0xae
  v_or_b32 v145, v55, v56
  v_mov_b32_dpp v146, v144 row_ror:8 row_mask:0xf bank_mask:0xf
  s_nop 0
  v_mov_b32_dpp v147, v145 row_ror:8 row_mask:0xf bank_mask:0xf
  buffer_store_dwordx4 v[144:147], v176, s[24:27], s37 offen sc1
  v_lshlrev_b32 v159, 7, v1
  v_lshl_add_u32 v159, v2, 9, v159
  v_and_b32 v64, 3, v2
  v_lshl_add_u32 v64, v1, 2, v64
  v_cmp_gt_u32 vcc, 16, v2
  v_lshlrev_b32 v64, 7, v64
  v_add_u32 v64, 0x2000, v64
  v_cndmask_b32 v159, v64, v159, vcc

  s_lshr_b32 s52, s32, 1
  s_and_b32 s53, s32, 1
  s_lshl_b32 s53, s53, 10
  s_add_u32 s53, s53, 8192
  s_mul_i32 s38, s52, 30720
  s_add_u32 s38, s38, s53
  v_add_u32 v5, s38, v17
  s_mul_i32 s38, s52, -10240
  s_add_u32 s38, s38, 20480
  s_add_u32 s38, s38, s53
  v_add_u32 v6, s38, v17
  v_lshl_add_u32 v9, v1, 12, v17
  v_add_u32 v9, 49152, v9
  v_xor_b32 v10, 0x1000, v9
  v_xor_b32 v11, 0x2000, v9
  v_xor_b32 v12, 0x3000, v9

  v_lshlrev_b32 v184, 16, v88
  v_and_b32 v185, 0xffff0000, v88
  v_lshlrev_b32 v186, 16, v89
  v_and_b32 v187, 0xffff0000, v89
  v_lshlrev_b32 v188, 16, v90
  v_and_b32 v189, 0xffff0000, v90
  v_lshlrev_b32 v190, 16, v91
  v_and_b32 v191, 0xffff0000, v91
  s_mov_b32 s52, 0x3fc03fc0
  v_log_f32 v192, v184
  v_xor_b32 v92, s52, v92
  v_log_f32 v193, v185
  v_xor_b32 v93, s52, v93
  v_log_f32 v194, v186
  v_xor_b32 v94, s52, v94
  v_log_f32 v195, v187
  v_xor_b32 v95, s52, v95
  v_log_f32 v196, v188
  v_or3_b32 v92, v92, v93, v94
  v_log_f32 v197, v189
  v_or_b32 v92, v92, v95
  v_log_f32 v198, v190
  v_mov_b32 v95, 0x7fc00000
  v_log_f32 v199, v191
  v_cmp_eq_u32 s[52:53], 0, v92
  v_rcp_f32 v200, v184
  ds_write_b128 v179, v[192:195] offset:28160
  ds_write_b128 v179, v[196:199] offset:28176
  v_max3_f32 v93, |v192|, |v193|, |v194|
  v_rcp_f32 v201, v185
  v_max3_f32 v94, |v195|, |v196|, |v197|
  v_rcp_f32 v202, v186
  v_max3_f32 v93, |v198|, |v199|, v93
  v_rcp_f32 v203, v187
  v_max_f32 v93, v93, v94
  v_rcp_f32 v204, v188
  v_cmp_gt_f32 vcc, 0x41f00000, v93
  v_rcp_f32 v205, v189
  s_nop 0
  v_rcp_f32 v206, v190
  s_and_b64 vcc, vcc, s[52:53]
  v_rcp_f32 v207, v191
  v_cndmask_b32 v200, v95, v200, vcc
  v_cvt_pk_bf16_f32 v184, v200, v201
  v_cvt_pk_bf16_f32 v185, v202, v203
  v_cvt_pk_bf16_f32 v186, v204, v205
  v_cvt_pk_bf16_f32 v187, v206, v207
  v_mov_b32 v92, 0
  v_mov_b32 v93, 0
  v_lshlrev_b32 v94, 16, v184
  v_and_b32 v95, 0xffff0000, v184
  v_sub_f32 v94, v200, v94
  v_sub_f32 v95, v201, v95
  v_cvt_pk_bf16_f32 v188, v94, v95
  v_lshlrev_b32 v94, 16, v185
  v_and_b32 v95, 0xffff0000, v185
  v_sub_f32 v94, v202, v94
  v_sub_f32 v95, v203, v95
  v_cvt_pk_bf16_f32 v189, v94, v95
  v_lshlrev_b32 v94, 16, v186
  v_and_b32 v95, 0xffff0000, v186
  v_sub_f32 v94, v204, v94
  v_sub_f32 v95, v205, v95
  v_cvt_pk_bf16_f32 v190, v94, v95
  v_lshlrev_b32 v94, 16, v187
  v_and_b32 v95, 0xffff0000, v187
  v_sub_f32 v94, v206, v94
  v_sub_f32 v95, v207, v95
  v_cvt_pk_bf16_f32 v191, v94, v95
  ds_write2_b64 v171, v[184:185], v[188:189] offset0:0 offset1:2
  ds_write2_b64 v171, v[186:187], v[190:191] offset0:6 offset1:8
  ds_write2_b64 v171, v[92:93], v[92:93] offset0:4 offset1:10
  s_xor_b32 s38, s34, 1
  s_lshl_b32 s38, s38, 11
  v_and_b32 v20, 31, v2
  v_lshl_add_u32 v20, v20, 6, s38
  v_and_b32 v15, 31, v2
  v_lshlrev_b32 v15, 5, v15
  v_lshlrev_b32 v14, 5, v2
  v_lshl_add_u32 v14, v1, 3, v14
  v_cmp_gt_u32 vcc, 16, v2
  v_add_u32 v22, 9216, v14
  s_nop 0
  v_cndmask_b32 v14, v14, v22, vcc
  s_sub_u32 s38, 2, s36
  s_mul_i32 s38, s38, 1024
  v_add_u32 v0, s38, v18
  s_xor_b32 s55, s54, 0x40000
  s_lshl_b32 s56, s57, 13
  s_lshl_b32 s38, s32, 6
  s_add_u32 s56, s56, s38
  s_mov_b32 s28, s20
  s_and_b32 s29, s21, 0xffff
  s_mov_b32 s30, 0x200000
  s_mov_b32 s31, 0x20000
  v_and_b32 v7, 31, v2
  v_lshl_add_u32 v7, v1, 5, v7
  v_mul_u32_u24 v7, 80, v7
  v_and_b32 v22, 32, v2
  v_add_u32 v7, v7, v22
  v_lshrrev_b32 v16, 2, v2
  v_lshl_add_u32 v8, v1, 5, v16
  v_mul_u32_u24 v8, 80, v8
  v_and_b32 v22, 48, v17
  v_add_u32 v8, v8, v22
  v_lshl_add_u32 v16, v16, 8, v22
  s_mul_i32 s40, s39, 0x9E3779B1
  s_add_u32 s40, s40, 0x7F4A7C15
  s_and_b32 s40, s40, 0xfffffff0
  s_or_b32 s62, s40, s41
  s_lshl_b32 s63, s35, 2
  s_add_u32 s63, s63, s59
  v_mov_b32 v24, s62
  s_or_b32 s61, s40, 8
  s_lshl_b32 s18, s57, 6
  s_add_u32 s18, s18, 8192
  v_mov_b32 v236, s61

  s_waitcnt vmcnt(0) lgkmcnt(0)
  buffer_load_dword v254, v159, s[24:27], s37 offen sc1
  s_barrier
  buffer_store_dword v24, v19, s[24:27], s63 offen
  buffer_store_dword v236, v19, s[24:27], s18 offen sc1
  s_mov_b32 s52, 0x05040100
  s_mov_b32 s53, 0x07060302
  v_perm_b32 v32, v80, v72, s52
  v_perm_b32 v33, v80, v72, s53
  v_perm_b32 v34, v81, v73, s52
  v_perm_b32 v35, v81, v73, s53
  v_perm_b32 v40, v84, v76, s52
  v_perm_b32 v41, v84, v76, s53
  v_perm_b32 v42, v85, v77, s52
  v_perm_b32 v43, v85, v77, s53
  v_dot2_f32_bf16 v192, v32, v112, 0 neg_hi:[0,1,0]
  v_dot2_f32_bf16 v193, v33, v113, 0 neg_hi:[0,1,0]
  v_dot2_f32_bf16 v194, v34, v114, 0 neg_hi:[0,1,0]
  v_dot2_f32_bf16 v195, v35, v115, 0 neg_hi:[0,1,0]
  v_dot2_f32_bf16 v196, v40, v120, 0 neg_hi:[0,1,0]
  v_dot2_f32_bf16 v197, v41, v121, 0 neg_hi:[0,1,0]
  v_dot2_f32_bf16 v198, v42, v122, 0 neg_hi:[0,1,0]
  v_dot2_f32_bf16 v199, v43, v123, 0 neg_hi:[0,1,0]
  v_cvt_pk_bf16_f32 v208, v192, v193
  v_cvt_pk_bf16_f32 v209, v194, v195
  v_cvt_pk_bf16_f32 v210, v196, v197
  v_cvt_pk_bf16_f32 v211, v198, v199
  v_dot2_f32_bf16 v200, v32, v128, 0
  v_dot2_f32_bf16 v201, v33, v129, 0
  v_dot2_f32_bf16 v202, v34, v130, 0
  v_dot2_f32_bf16 v203, v35, v131, 0
  v_dot2_f32_bf16 v204, v40, v136, 0
  v_dot2_f32_bf16 v205, v41, v137, 0
  v_dot2_f32_bf16 v206, v42, v138, 0
  v_dot2_f32_bf16 v207, v43, v139, 0
  ds_write_b128 v180, v[208:211] offset:11264
  v_cvt_pk_bf16_f32 v212, v200, v201
  v_cvt_pk_bf16_f32 v213, v202, v203
  v_cvt_pk_bf16_f32 v214, v204, v205
  v_cvt_pk_bf16_f32 v215, v206, v207
  v_perm_b32 v36, v82, v74, s52
  v_perm_b32 v37, v82, v74, s53
  v_perm_b32 v38, v83, v75, s52
  v_perm_b32 v39, v83, v75, s53
  v_perm_b32 v44, v86, v78, s52
  v_perm_b32 v45, v86, v78, s53
  v_perm_b32 v46, v87, v79, s52
  v_perm_b32 v47, v87, v79, s53
  v_dot2_f32_bf16 v192, v36, v116, 0 neg_hi:[0,1,0]
  v_dot2_f32_bf16 v193, v37, v117, 0 neg_hi:[0,1,0]
  v_dot2_f32_bf16 v194, v38, v118, 0 neg_hi:[0,1,0]
  v_dot2_f32_bf16 v195, v39, v119, 0 neg_hi:[0,1,0]
  v_dot2_f32_bf16 v196, v44, v124, 0 neg_hi:[0,1,0]
  v_dot2_f32_bf16 v197, v45, v125, 0 neg_hi:[0,1,0]
  v_dot2_f32_bf16 v198, v46, v126, 0 neg_hi:[0,1,0]
  v_dot2_f32_bf16 v199, v47, v127, 0 neg_hi:[0,1,0]
  ds_write_b128 v180, v[212:215] offset:15488
  v_cvt_pk_bf16_f32 v216, v192, v193
  v_cvt_pk_bf16_f32 v217, v194, v195
  v_cvt_pk_bf16_f32 v218, v196, v197
  v_cvt_pk_bf16_f32 v219, v198, v199
  v_dot2_f32_bf16 v200, v36, v132, 0
  v_dot2_f32_bf16 v201, v37, v133, 0
  v_dot2_f32_bf16 v202, v38, v134, 0
  v_dot2_f32_bf16 v203, v39, v135, 0
  v_dot2_f32_bf16 v204, v44, v140, 0
  v_dot2_f32_bf16 v205, v45, v141, 0
  v_dot2_f32_bf16 v206, v46, v142, 0
  v_dot2_f32_bf16 v207, v47, v143, 0
  ds_write_b128 v180, v[216:219] offset:11792
  v_cvt_pk_bf16_f32 v220, v200, v201
  v_cvt_pk_bf16_f32 v221, v202, v203
  v_cvt_pk_bf16_f32 v222, v204, v205
  v_cvt_pk_bf16_f32 v223, v206, v207
  ds_write_b128 v180, v[220:223] offset:16016
  v_bfe_u32 v232, v2, 3, 2
  v_bfe_u32 v233, v2, 1, 1
  v_lshl_add_u32 v232, v232, 1, v233
  v_lshrrev_b32 v233, 3, v2
  v_xor_b32 v233, v233, v2
  v_and_b32 v233, 4, v233
  v_lshl_add_u32 v232, v233, 1, v232
  v_and_b32 v233, 1, v2
  v_lshlrev_b32 v233, 4, v233
  v_mov_b32 v234, 0x3f80
  v_lshlrev_b32 v233, v233, v234

  v_cmp_eq_u32 vcc, 0, v232
  v_cmp_eq_u32 s[52:53], 1, v232
  v_cmp_eq_u32 s[100:101], 2, v232
  v_cndmask_b32 v224, 0, v233, vcc
  v_cmp_eq_u32 vcc, 3, v232
  v_cndmask_b32 v225, 0, v233, s[52:53]
  v_cmp_eq_u32 s[52:53], 4, v232
  v_cndmask_b32 v226, 0, v233, s[100:101]
  v_cmp_eq_u32 s[100:101], 5, v232
  v_cndmask_b32 v227, 0, v233, vcc
  v_cmp_eq_u32 vcc, 6, v232
  v_cndmask_b32 v228, 0, v233, s[52:53]
  v_cmp_eq_u32 s[52:53], 7, v232
  v_cndmask_b32 v229, 0, v233, s[100:101]
  v_cndmask_b32 v230, 0, v233, vcc
  v_cndmask_b32 v231, 0, v233, s[52:53]
  ds_write_b128 v9, v[224:227] offset:49152
  ds_write_b128 v9, v[228:231] offset:50176
  buffer_load_dword v26, v237, s[24:27], s59 offen sc1
  s_lshl_b32 s60, s33, 12
  s_add_u32 s60, s60, 8192

  s_mov_b32 s19, 0

  s_mov_b64 exec, 0
  s_cmp_eq_u32 s32, 0
  s_cbranch_scc1 L_hook0
  s_cmp_eq_u32 s32, 1
  s_cbranch_scc1 L_hook1
  s_cmp_eq_u32 s32, 2
  s_cbranch_scc1 L_hook2
L_warmed:
  s_mov_b64 exec, -1
L_pollA:
  s_waitcnt vmcnt(0)
  v_cmp_eq_u32 vcc, s62, v26
  s_cmp_eq_u64 vcc, -1

  s_cbranch_scc0 L_pollA_more
L_go:
  buffer_load_dwordx4 a[64:67], v3, s[24:27], s42 offen offset:0 sc1
  buffer_load_dwordx4 a[68:71], v3, s[24:27], s42 offen offset:1024 sc1
  s_waitcnt lgkmcnt(0)
  s_barrier
  ds_read_b128 v[180:183], v13 offset:28160
  ds_read_b128 v[184:187], v13 offset:28192
  ds_read_b128 v[188:191], v13 offset:28224
  buffer_load_dwordx4 a[72:75], v3, s[24:27], s42 offen offset:2048 sc1
  ds_read_b128 v[192:195], v13 offset:28256
  ds_read_b128 a[0:3], v23 offset:11264
  ds_read_b128 a[32:35], v23 offset:19712
  buffer_load_dwordx4 a[76:79], v3, s[24:27], s42 offen offset:3072 sc1
  ds_read_b128 a[4:7], v23 offset:12320
  ds_read_b128 a[36:39], v23 offset:20768
  ds_read_b128 a[8:11], v23 offset:13376
  buffer_load_dwordx4 a[80:83], v4, s[24:27], s42 offen offset:0 sc1
  ds_read_b128 a[40:43], v23 offset:21824
  ds_read_b128 a[12:15], v23 offset:14432
  ds_read_b128 a[44:47], v23 offset:22880
  buffer_load_dwordx4 a[84:87], v4, s[24:27], s42 offen offset:1024 sc1
  ds_read_b128 a[16:19], v23 offset:15488
  ds_read_b128 a[48:51], v23 offset:23936
  s_waitcnt vmcnt(5) lgkmcnt(9)
  v_mfma_f32_32x32x16_bf16 v[24:39], a[64:67], a[0:3], v[180:195]
  s_waitcnt lgkmcnt(8)
  ds_read_b128 a[20:23], v23 offset:16544
  v_mfma_f32_32x32x16_bf16 v[40:55], a[64:67], a[32:35], v[180:195]
  s_waitcnt vmcnt(4) lgkmcnt(8)
  ds_read_b128 a[52:55], v23 offset:24992
  v_mfma_f32_32x32x16_bf16 v[24:39], a[68:71], a[4:7], v[24:39]
  s_waitcnt lgkmcnt(8)
  ds_read_b128 a[24:27], v23 offset:17600
  v_mfma_f32_32x32x16_bf16 v[40:55], a[68:71], a[36:39], v[40:55]
  s_waitcnt vmcnt(3) lgkmcnt(8)
  ds_read_b128 a[56:59], v23 offset:26048
  buffer_load_dwordx4 a[88:91], v4, s[24:27], s42 offen offset:2048 sc1
  v_mfma_f32_32x32x16_bf16 v[24:39], a[72:75], a[8:11], v[24:39]
  s_waitcnt lgkmcnt(8)
  ds_read_b128 v[196:199], v13 offset:28672
  v_mfma_f32_32x32x16_bf16 v[40:55], a[72:75], a[40:43], v[40:55]
  s_waitcnt vmcnt(3) lgkmcnt(8)
  ds_read_b128 a[28:31], v23 offset:18656
  buffer_load_dwordx4 a[92:95], v4, s[24:27], s42 offen offset:3072 sc1
  v_mfma_f32_32x32x16_bf16 v[24:39], a[76:79], a[12:15], v[24:39]
  s_waitcnt lgkmcnt(8)
  ds_read_b128 a[208:211], v21 offset:36352
  v_mfma_f32_32x32x16_bf16 v[40:55], a[76:79], a[44:47], v[40:55]
  s_waitcnt vmcnt(3) lgkmcnt(8)
  ds_read_b128 v[200:203], v13 offset:28704
  buffer_load_dwordx4 a[96:99], v3, s[24:27], s43 offen offset:0 sc1
  v_mfma_f32_32x32x16_bf16 v[24:39], a[80:83], a[16:19], v[24:39]
  s_waitcnt lgkmcnt(8)
  ds_read_b128 a[60:63], v23 offset:27104
  v_mfma_f32_32x32x16_bf16 v[40:55], a[80:83], a[48:51], v[40:55]
  s_waitcnt vmcnt(3) lgkmcnt(8)
  ds_read_b128 v[204:207], v13 offset:28736
  buffer_load_dwordx4 a[100:103], v3, s[24:27], s43 offen offset:1024 sc1
  v_mfma_f32_32x32x16_bf16 v[24:39], a[84:87], a[20:23], v[24:39]
  s_waitcnt lgkmcnt(8)
  ds_read_b128 v[208:211], v13 offset:28768
  v_mfma_f32_32x32x16_bf16 v[40:55], a[84:87], a[52:55], v[40:55]
  s_waitcnt vmcnt(3) lgkmcnt(8)
  ds_read_b128 a[212:215], v21 offset:36448
  buffer_load_dwordx4 a[104:107], v3, s[24:27], s43 offen offset:2048 sc1
  v_mfma_f32_32x32x16_bf16 v[24:39], a[88:91], a[24:27], v[24:39]
  s_waitcnt lgkmcnt(8)
  ds_read_b128 a[216:219], v21 offset:37120
  v_mfma_f32_32x32x16_bf16 v[40:55], a[88:91], a[56:59], v[40:55]
  s_waitcnt vmcnt(3) lgkmcnt(7)
  ds_read_b128 a[220:223], v21 offset:37216
  buffer_load_dwordx4 a[108:111], v3, s[24:27], s43 offen offset:3072 sc1
  v_mfma_f32_32x32x16_bf16 v[24:39], a[92:95], a[28:31], v[24:39]
  s_waitcnt lgkmcnt(5)
  v_mfma_f32_32x32x16_bf16 v[40:55], a[92:95], a[60:63], v[40:55]
  s_waitcnt vmcnt(3) lgkmcnt(3)
  buffer_load_dwordx4 a[112:115], v4, s[24:27], s43 offen offset:0 sc1
  v_mfma_f32_32x32x16_bf16 v[56:71], a[96:99], a[0:3], v[196:211]
  ds_read_b128 v[180:183], v13 offset:29184
  v_mfma_f32_32x32x16_bf16 v[72:87], a[96:99], a[32:35], v[196:211]
  s_waitcnt vmcnt(3)
  ds_read_b128 v[184:187], v13 offset:29216
  buffer_load_dwordx4 a[116:119], v4, s[24:27], s43 offen offset:1024 sc1
  s_nop 1
  v_exp_f32 v24, v24
  v_exp_f32 v25, v25
  v_mfma_f32_32x32x16_bf16 v[56:71], a[100:103], a[4:7], v[56:71]
  ds_read_b128 v[188:191], v13 offset:29248
  buffer_load_dwordx4 v[120:123], v5, s[24:27], s42 offen sc1
  v_exp_f32 v26, v26
  v_cvt_pk_bf16_f32 v88, v24, v25
  v_mfma_f32_32x32x16_bf16 v[72:87], a[100:103], a[36:39], v[72:87]
  s_waitcnt vmcnt(4)
  ds_read_b128 v[192:195], v13 offset:29280
  buffer_load_dwordx4 a[120:123], v4, s[24:27], s43 offen offset:2048 sc1
  v_exp_f32 v27, v27
  v_exp_f32 v28, v28
  v_cvt_pk_bf16_f32 v89, v26, v27
  v_exp_f32 v29, v29
  v_exp_f32 v30, v30
  v_cvt_pk_bf16_f32 v90, v28, v29
  v_mfma_f32_32x32x16_bf16 v[56:71], a[104:107], a[8:11], v[56:71]
  v_exp_f32 v31, v31
  v_exp_f32 v32, v32
  v_cvt_pk_bf16_f32 v91, v30, v31
  v_exp_f32 v33, v33
  v_exp_f32 v34, v34
  v_cvt_pk_bf16_f32 v92, v32, v33
  v_mfma_f32_32x32x16_bf16 v[72:87], a[104:107], a[40:43], v[72:87]
  s_waitcnt vmcnt(4)
  ds_write_b128 v9, v[88:91] offset:0
  v_exp_f32 v35, v35
  v_exp_f32 v36, v36
  v_cvt_pk_bf16_f32 v93, v34, v35
  v_exp_f32 v37, v37
  v_mfma_f32_16x16x32_bf16 v[228:231], a[208:211], v[88:91], 0
  v_exp_f32 v38, v38
  v_mfma_f32_32x32x16_bf16 v[56:71], a[108:111], a[12:15], v[56:71]
  buffer_load_dwordx4 a[124:127], v4, s[24:27], s43 offen offset:3072 sc1
  v_cvt_pk_bf16_f32 v94, v36, v37
  v_exp_f32 v39, v39
  v_exp_f32 v40, v40
  v_cvt_pk_bf16_f32 v95, v38, v39
  v_exp_f32 v41, v41
  v_mfma_f32_32x32x16_bf16 v[72:87], a[108:111], a[44:47], v[72:87]
  s_waitcnt vmcnt(4) lgkmcnt(7)
  ds_write_b128 v9, v[92:95] offset:1024
  v_exp_f32 v42, v42
  v_cvt_pk_bf16_f32 v96, v40, v41
  v_exp_f32 v43, v43
  v_exp_f32 v44, v44
  v_cvt_pk_bf16_f32 v97, v42, v43
  v_exp_f32 v45, v45
  v_mfma_f32_16x16x32_bf16 v[228:231], a[212:215], v[92:95], v[228:231]
  v_exp_f32 v46, v46
  v_mfma_f32_32x32x16_bf16 v[56:71], a[112:115], a[16:19], v[56:71]
  buffer_load_dwordx4 v[124:127], v6, s[24:27], s42 offen sc1
  v_cvt_pk_bf16_f32 v98, v44, v45
  v_exp_f32 v47, v47
  v_exp_f32 v48, v48
  v_cvt_pk_bf16_f32 v99, v46, v47
  v_mfma_f32_32x32x16_bf16 v[72:87], a[112:115], a[48:51], v[72:87]
  s_waitcnt vmcnt(4)
  ds_write_b128 v9, v[96:99] offset:2048
  v_exp_f32 v49, v49
  v_exp_f32 v50, v50
  v_cvt_pk_bf16_f32 v100, v48, v49
  v_exp_f32 v51, v51
  v_exp_f32 v52, v52
  v_cvt_pk_bf16_f32 v101, v50, v51
  v_mfma_f32_16x16x32_bf16 v[232:235], a[208:211], v[96:99], 0
  v_exp_f32 v53, v53
  v_mfma_f32_32x32x16_bf16 v[56:71], a[116:119], a[20:23], v[56:71]
  s_waitcnt vmcnt(3)
  buffer_load_dwordx4 a[128:131], v3, s[24:27], s44 offen offset:0 sc1
  v_exp_f32 v54, v54
  v_cvt_pk_bf16_f32 v102, v52, v53
  v_exp_f32 v55, v55
  s_nop 0
  v_cvt_pk_bf16_f32 v103, v54, v55
  v_mfma_f32_32x32x16_bf16 v[72:87], a[116:119], a[52:55], v[72:87]
  s_waitcnt vmcnt(3)
  ds_write_b128 v9, v[100:103] offset:3072
  v_mfma_f32_16x16x32_bf16 v[232:235], a[212:215], v[100:103], v[232:235]
  v_cvt_scalef32_pk_bf16_fp4 v152, v120, 1.0 op_sel:[0,0,0]
  v_cvt_scalef32_pk_bf16_fp4 v153, v120, 1.0 op_sel:[1,0,0]
  v_mfma_f32_32x32x16_bf16 v[56:71], a[120:123], a[24:27], v[56:71]
  buffer_load_dwordx4 a[132:135], v3, s[24:27], s44 offen offset:1024 sc1
  v_cvt_scalef32_pk_bf16_fp4 v154, v120, 1.0 op_sel:[0,1,0]
  v_cvt_scalef32_pk_bf16_fp4 v155, v120, 1.0 op_sel:[1,1,0]
  v_cvt_scalef32_pk_bf16_fp4 v156, v121, 1.0 op_sel:[0,0,0]
  v_cvt_scalef32_pk_bf16_fp4 v157, v121, 1.0 op_sel:[1,0,0]
  v_mfma_f32_32x32x16_bf16 v[72:87], a[120:123], a[56:59], v[72:87]
  s_waitcnt vmcnt(3) lgkmcnt(0)
  s_barrier
  ds_read_b128 a[160:163], v10 offset:0
  v_mfma_f32_32x32x16_bf16 v[56:71], a[124:127], a[28:31], v[56:71]
  ds_read_b128 a[164:167], v10 offset:2048
  buffer_load_dwordx4 a[136:139], v3, s[24:27], s44 offen offset:2048 sc1
  v_cvt_scalef32_pk_bf16_fp4 v158, v121, 1.0 op_sel:[0,1,0]
  v_cvt_scalef32_pk_bf16_fp4 v159, v121, 1.0 op_sel:[1,1,0]
  v_cvt_scalef32_pk_bf16_fp4 v160, v122, 1.0 op_sel:[0,0,0]
  v_mfma_f32_32x32x16_bf16 v[72:87], a[124:127], a[60:63], v[72:87]
  ds_read_b128 a[168:171], v10 offset:1024
  buffer_load_dwordx4 a[140:143], v3, s[24:27], s44 offen offset:3072 sc1
  v_cvt_scalef32_pk_bf16_fp4 v161, v122, 1.0 op_sel:[1,0,0]
  v_cvt_scalef32_pk_bf16_fp4 v162, v122, 1.0 op_sel:[0,1,0]
  v_cvt_scalef32_pk_bf16_fp4 v163, v122, 1.0 op_sel:[1,1,0]
  v_mfma_f32_32x32x16_bf16 v[236:251], v[152:155], v[88:91], 0
  ds_read_b128 a[172:175], v10 offset:3072
  v_cvt_scalef32_pk_bf16_fp4 v164, v123, 1.0 op_sel:[0,0,0]
  v_cvt_scalef32_pk_bf16_fp4 v165, v123, 1.0 op_sel:[1,0,0]
  v_cvt_scalef32_pk_bf16_fp4 v166, v123, 1.0 op_sel:[0,1,0]
  v_cvt_scalef32_pk_bf16_fp4 v167, v123, 1.0 op_sel:[1,1,0]
  v_mfma_f32_32x32x16_bf16 v[212:227], v[152:155], v[96:99], 0
  s_waitcnt vmcnt(4)
  ds_read_b128 a[176:179], v11 offset:0
  buffer_load_dwordx4 a[144:147], v4, s[24:27], s44 offen offset:0 sc1
  v_exp_f32 v56, v56
  v_cvt_scalef32_pk_bf16_fp4 v168, v124, 1.0 op_sel:[0,0,0]
  v_mfma_f32_32x32x16_bf16 v[236:251], v[156:159], v[92:95], v[236:251]
  ds_read_b128 a[180:183], v11 offset:2048
  v_exp_f32 v57, v57
  v_exp_f32 v58, v58
  v_cvt_scalef32_pk_bf16_fp4 v169, v124, 1.0 op_sel:[1,0,0]
  v_mfma_f32_32x32x16_bf16 v[212:227], v[156:159], v[100:103], v[212:227]
  s_waitcnt lgkmcnt(5)
  ds_read_b128 a[184:187], v11 offset:1024
  buffer_load_dwordx4 a[148:151], v4, s[24:27], s44 offen offset:1024 sc1
  v_cvt_pk_bf16_f32 v104, v56, v57
  v_cvt_scalef32_pk_bf16_fp4 v170, v124, 1.0 op_sel:[0,1,0]
  v_cvt_scalef32_pk_bf16_fp4 v171, v124, 1.0 op_sel:[1,1,0]
  v_mfma_f32_32x32x16_bf16 v[236:251], v[160:163], a[160:163], v[236:251]
  s_waitcnt lgkmcnt(5)
  ds_read_b128 a[188:191], v11 offset:3072
  v_exp_f32 v59, v59
  v_exp_f32 v60, v60
  v_cvt_scalef32_pk_bf16_fp4 v172, v125, 1.0 op_sel:[0,0,0]
  v_mfma_f32_32x32x16_bf16 v[212:227], v[160:163], a[164:167], v[212:227]
  s_waitcnt lgkmcnt(5)
  ds_read_b128 a[192:195], v12 offset:0
  buffer_load_dwordx4 a[152:155], v4, s[24:27], s44 offen offset:2048 sc1
  v_cvt_pk_bf16_f32 v105, v58, v59
  v_cvt_scalef32_pk_bf16_fp4 v173, v125, 1.0 op_sel:[1,0,0]
  v_cvt_scalef32_pk_bf16_fp4 v174, v125, 1.0 op_sel:[0,1,0]
  v_mfma_f32_32x32x16_bf16 v[236:251], v[164:167], a[168:171], v[236:251]
  s_waitcnt lgkmcnt(5)
  ds_read_b128 a[196:199], v12 offset:2048
  v_exp_f32 v61, v61
  v_exp_f32 v62, v62
  v_cvt_pk_bf16_f32 v106, v60, v61
  v_mfma_f32_32x32x16_bf16 v[212:227], v[164:167], a[172:175], v[212:227]
  s_waitcnt lgkmcnt(5)
  ds_read_b128 a[200:203], v12 offset:1024
  v_cvt_scalef32_pk_bf16_fp4 v175, v125, 1.0 op_sel:[1,1,0]
L_hook0:
  s_cbranch_execz L_warmed
  v_exp_f32 v63, v63
  v_cvt_scalef32_pk_bf16_fp4 v176, v126, 1.0 op_sel:[0,0,0]
  v_cvt_scalef32_pk_bf16_fp4 v177, v126, 1.0 op_sel:[1,0,0]
  v_mfma_f32_32x32x16_bf16 v[236:251], v[168:171], a[176:179], v[236:251]
  s_waitcnt lgkmcnt(5)
  ds_read_b128 a[204:207], v12 offset:3072
  buffer_load_dwordx4 a[156:159], v4, s[24:27], s44 offen offset:3072 sc1
  v_exp_f32 v64, v64
  v_cvt_pk_bf16_f32 v107, v62, v63
  v_mfma_f32_32x32x16_bf16 v[212:227], v[168:171], a[180:183], v[212:227]
  s_waitcnt lgkmcnt(5)
  ds_write_b128 v9, v[104:107] offset:16384
  v_mfma_f32_16x16x32_bf16 v[228:231], a[216:219], v[104:107], v[228:231]
  v_cvt_scalef32_pk_bf16_fp4 v178, v126, 1.0 op_sel:[0,1,0]
  v_exp_f32 v65, v65
  v_mfma_f32_32x32x16_bf16 v[236:251], v[172:175], a[184:187], v[236:251]
  s_waitcnt lgkmcnt(5)
  buffer_load_dwordx4 v[128:131], v5, s[24:27], s43 offen sc1
  v_cvt_scalef32_pk_bf16_fp4 v179, v126, 1.0 op_sel:[1,1,0]
  v_exp_f32 v66, v66
  v_cvt_pk_bf16_f32 v108, v64, v65
  v_mfma_f32_32x32x16_bf16 v[212:227], v[172:175], a[188:191], v[212:227]
  s_waitcnt lgkmcnt(4)
  ds_read_b128 a[208:211], v21 offset:37888
  v_cvt_scalef32_pk_bf16_fp4 v152, v127, 1.0 op_sel:[0,0,0]
  v_exp_f32 v67, v67
  v_cvt_scalef32_pk_bf16_fp4 v153, v127, 1.0 op_sel:[1,0,0]
  v_cvt_scalef32_pk_bf16_fp4 v154, v127, 1.0 op_sel:[0,1,0]
  v_mfma_f32_32x32x16_bf16 v[236:251], v[176:179], a[192:195], v[236:251]
  s_waitcnt lgkmcnt(4)
  ds_read_b128 a[212:215], v21 offset:37984
  buffer_load_dwordx4 v[132:135], v6, s[24:27], s43 offen sc1
  v_exp_f32 v68, v68
  v_cvt_pk_bf16_f32 v109, v66, v67
  v_cvt_scalef32_pk_bf16_fp4 v155, v127, 1.0 op_sel:[1,1,0]
  v_mfma_f32_32x32x16_bf16 v[212:227], v[176:179], a[196:199], v[212:227]
  s_waitcnt lgkmcnt(4)
  v_exp_f32 v69, v69
  v_exp_f32 v70, v70
  v_cvt_pk_bf16_f32 v110, v68, v69
  v_exp_f32 v71, v71
  v_mfma_f32_32x32x16_bf16 v[236:251], v[152:155], a[200:203], v[236:251]
  s_waitcnt lgkmcnt(3)
  buffer_load_dwordx4 v[136:139], v5, s[24:27], s44 offen sc1
  v_exp_f32 v72, v72
  v_cvt_pk_bf16_f32 v111, v70, v71
  v_exp_f32 v73, v73
  v_mfma_f32_32x32x16_bf16 v[212:227], v[152:155], a[204:207], v[212:227]
  s_waitcnt vmcnt(10)
  ds_write_b128 v9, v[108:111] offset:17408
  v_mfma_f32_16x16x32_bf16 v[228:231], a[220:223], v[108:111], v[228:231]
  v_exp_f32 v74, v74
  v_mfma_f32_32x32x16_bf16 v[24:39], a[128:131], a[0:3], v[180:195]
  s_waitcnt vmcnt(9)
  buffer_load_dwordx4 v[140:143], v6, s[24:27], s44 offen sc1
  v_cvt_pk_bf16_f32 v112, v72, v73
  v_exp_f32 v75, v75
  v_exp_f32 v76, v76
  v_mfma_f32_32x32x16_bf16 v[24:39], a[132:135], a[4:7], v[24:39]
  s_waitcnt vmcnt(9)
  ds_read_b128 v[196:199], v13 offset:29696
  buffer_load_dwordx4 a[224:227], v3, s[24:27], s45 offen offset:0 sc1
  v_cvt_pk_bf16_f32 v113, v74, v75
  v_exp_f32 v77, v77
  v_mfma_f32_32x32x16_bf16 v[24:39], a[136:139], a[8:11], v[24:39]
  s_waitcnt vmcnt(9)
  ds_read_b128 v[200:203], v13 offset:29728
  v_exp_f32 v78, v78
  v_cvt_pk_bf16_f32 v114, v76, v77
  v_exp_f32 v79, v79
  v_mfma_f32_32x32x16_bf16 v[24:39], a[140:143], a[12:15], v[24:39]
  s_waitcnt vmcnt(8)
  ds_read_b128 v[204:207], v13 offset:29760
  v_exp_f32 v80, v80
  v_cvt_pk_bf16_f32 v115, v78, v79
  v_mfma_f32_32x32x16_bf16 v[24:39], a[144:147], a[16:19], v[24:39]
  s_waitcnt vmcnt(7)
  ds_write_b128 v9, v[112:115] offset:18432
  v_mfma_f32_16x16x32_bf16 v[232:235], a[216:219], v[112:115], v[232:235]
  v_exp_f32 v81, v81
  v_mfma_f32_32x32x16_bf16 v[24:39], a[148:151], a[20:23], v[24:39]
  s_waitcnt vmcnt(6)
  buffer_load_dwordx4 a[228:231], v3, s[24:27], s45 offen offset:1024 sc1
  v_exp_f32 v82, v82
  v_cvt_pk_bf16_f32 v116, v80, v81
  v_exp_f32 v83, v83
  v_mfma_f32_32x32x16_bf16 v[24:39], a[152:155], a[24:27], v[24:39]
  s_waitcnt vmcnt(6)
  ds_read_b128 v[208:211], v13 offset:29792
  buffer_load_dwordx4 a[232:235], v3, s[24:27], s45 offen offset:2048 sc1
  v_exp_f32 v84, v84
  v_cvt_pk_bf16_f32 v117, v82, v83
  v_mfma_f32_32x32x16_bf16 v[24:39], a[156:159], a[28:31], v[24:39]
  v_exp_f32 v85, v85
  v_exp_f32 v86, v86
  v_cvt_pk_bf16_f32 v118, v84, v85
  v_mfma_f32_32x32x16_bf16 v[40:55], a[128:131], a[32:35], v[180:195]
  s_waitcnt vmcnt(6)
  buffer_load_dword v22, v20, s[24:27], s60 offen sc1
  v_exp_f32 v87, v87
  s_nop 0
  v_cvt_pk_bf16_f32 v119, v86, v87
  v_cvt_scalef32_pk_bf16_fp4 v156, v128, 1.0 op_sel:[0,0,0]
  v_mfma_f32_32x32x16_bf16 v[40:55], a[132:135], a[36:39], v[40:55]
  ds_write_b128 v9, v[116:119] offset:19456
  v_mfma_f32_16x16x32_bf16 v[232:235], a[220:223], v[116:119], v[232:235]
  v_cvt_scalef32_pk_bf16_fp4 v157, v128, 1.0 op_sel:[1,0,0]
  v_cvt_scalef32_pk_bf16_fp4 v158, v128, 1.0 op_sel:[0,1,0]
  v_mfma_f32_32x32x16_bf16 v[40:55], a[136:139], a[40:43], v[40:55]
  buffer_load_dwordx4 a[236:239], v3, s[24:27], s45 offen offset:3072 sc1
  v_cvt_scalef32_pk_bf16_fp4 v159, v128, 1.0 op_sel:[1,1,0]
  v_cvt_scalef32_pk_bf16_fp4 v160, v129, 1.0 op_sel:[0,0,0]
  v_cvt_scalef32_pk_bf16_fp4 v161, v129, 1.0 op_sel:[1,0,0]
  v_cvt_scalef32_pk_bf16_fp4 v162, v129, 1.0 op_sel:[0,1,0]
  v_mfma_f32_32x32x16_bf16 v[40:55], a[140:143], a[44:47], v[40:55]
  buffer_load_dwordx4 a[240:243], v4, s[24:27], s45 offen offset:0 sc1
  v_cvt_scalef32_pk_bf16_fp4 v163, v129, 1.0 op_sel:[1,1,0]
  v_cvt_scalef32_pk_bf16_fp4 v164, v130, 1.0 op_sel:[0,0,0]
  v_cvt_scalef32_pk_bf16_fp4 v165, v130, 1.0 op_sel:[1,0,0]
  v_cvt_scalef32_pk_bf16_fp4 v166, v130, 1.0 op_sel:[0,1,0]
  v_mfma_f32_32x32x16_bf16 v[40:55], a[144:147], a[48:51], v[40:55]
  v_cvt_scalef32_pk_bf16_fp4 v167, v130, 1.0 op_sel:[1,1,0]
  v_cvt_scalef32_pk_bf16_fp4 v168, v131, 1.0 op_sel:[0,0,0]
  v_cvt_scalef32_pk_bf16_fp4 v169, v131, 1.0 op_sel:[1,0,0]
  v_exp_f32 v24, v24
  v_cvt_scalef32_pk_bf16_fp4 v170, v131, 1.0 op_sel:[0,1,0]
  v_mfma_f32_32x32x16_bf16 v[40:55], a[148:151], a[52:55], v[40:55]
  s_waitcnt lgkmcnt(0)
  s_barrier
  ds_read_b128 a[160:163], v10 offset:16384
  v_mfma_f32_32x32x16_bf16 v[40:55], a[152:155], a[56:59], v[40:55]
  ds_read_b128 a[164:167], v10 offset:18432
  buffer_load_dwordx4 a[244:247], v4, s[24:27], s45 offen offset:1024 sc1
  v_cvt_scalef32_pk_bf16_fp4 v171, v131, 1.0 op_sel:[1,1,0]
  v_mfma_f32_32x32x16_bf16 v[40:55], a[156:159], a[60:63], v[40:55]
  s_waitcnt vmcnt(9)
  ds_read_b128 a[168:171], v10 offset:17408
  buffer_load_dwordx4 a[248:251], v4, s[24:27], s45 offen offset:2048 sc1
  v_exp_f32 v25, v25
  v_cvt_scalef32_pk_bf16_fp4 v172, v132, 1.0 op_sel:[0,0,0]
  v_mfma_f32_32x32x16_bf16 v[236:251], v[156:159], v[104:107], v[236:251]
  ds_read_b128 a[172:175], v10 offset:19456
  v_exp_f32 v26, v26
  v_cvt_pk_bf16_f32 v88, v24, v25
  v_cvt_scalef32_pk_bf16_fp4 v173, v132, 1.0 op_sel:[1,0,0]
  v_cvt_scalef32_pk_bf16_fp4 v174, v132, 1.0 op_sel:[0,1,0]
  v_mfma_f32_32x32x16_bf16 v[212:227], v[156:159], v[112:115], v[212:227]
  ds_read_b128 a[176:179], v11 offset:16384
  buffer_load_dwordx4 a[252:255], v4, s[24:27], s45 offen offset:3072 sc1
  v_exp_f32 v27, v27
  v_cvt_scalef32_pk_bf16_fp4 v175, v132, 1.0 op_sel:[1,1,0]
  v_mfma_f32_32x32x16_bf16 v[236:251], v[160:163], v[108:111], v[236:251]
  ds_read_b128 a[180:183], v11 offset:18432
  v_exp_f32 v28, v28
  v_cvt_pk_bf16_f32 v89, v26, v27
  v_cvt_scalef32_pk_bf16_fp4 v176, v133, 1.0 op_sel:[0,0,0]
  v_cvt_scalef32_pk_bf16_fp4 v177, v133, 1.0 op_sel:[1,0,0]
  v_mfma_f32_32x32x16_bf16 v[212:227], v[160:163], v[116:119], v[212:227]
  s_waitcnt lgkmcnt(5)
  ds_read_b128 a[184:187], v11 offset:17408
  buffer_load_dwordx4 v[144:147], v5, s[24:27], s45 offen sc1
  v_exp_f32 v29, v29
  v_cvt_scalef32_pk_bf16_fp4 v178, v133, 1.0 op_sel:[0,1,0]
  v_mfma_f32_32x32x16_bf16 v[236:251], v[164:167], a[160:163], v[236:251]
  s_waitcnt lgkmcnt(5)
  ds_read_b128 a[188:191], v11 offset:19456
  v_exp_f32 v30, v30
  v_cvt_pk_bf16_f32 v90, v28, v29
  v_cvt_scalef32_pk_bf16_fp4 v179, v133, 1.0 op_sel:[1,1,0]
  v_cvt_scalef32_pk_bf16_fp4 v152, v134, 1.0 op_sel:[0,0,0]
  v_mfma_f32_32x32x16_bf16 v[212:227], v[164:167], a[164:167], v[212:227]
  s_waitcnt lgkmcnt(5)
  ds_read_b128 a[192:195], v12 offset:16384
  buffer_load_dwordx4 v[148:151], v6, s[24:27], s45 offen sc1
  v_exp_f32 v31, v31
  v_cvt_scalef32_pk_bf16_fp4 v153, v134, 1.0 op_sel:[1,0,0]
  v_mfma_f32_32x32x16_bf16 v[236:251], v[168:171], a[168:171], v[236:251]
  s_waitcnt lgkmcnt(5)
  ds_read_b128 a[196:199], v12 offset:18432
  v_exp_f32 v32, v32
  v_cvt_pk_bf16_f32 v91, v30, v31
  v_cvt_scalef32_pk_bf16_fp4 v154, v134, 1.0 op_sel:[0,1,0]
  v_cvt_scalef32_pk_bf16_fp4 v155, v134, 1.0 op_sel:[1,1,0]
  v_mfma_f32_32x32x16_bf16 v[212:227], v[168:171], a[172:175], v[212:227]
  s_waitcnt lgkmcnt(5)
  ds_write_b128 v9, v[88:91] offset:32768
  v_mfma_f32_16x16x32_bf16 v[228:231], a[208:211], v[88:91], v[228:231]
  v_exp_f32 v33, v33
  v_mfma_f32_32x32x16_bf16 v[236:251], v[172:175], a[176:179], v[236:251]
  s_waitcnt lgkmcnt(5)
  v_exp_f32 v34, v34
  v_cvt_pk_bf16_f32 v92, v32, v33
  v_cvt_scalef32_pk_bf16_fp4 v156, v135, 1.0 op_sel:[0,0,0]
  v_exp_f32 v35, v35
  v_mfma_f32_32x32x16_bf16 v[212:227], v[172:175], a[180:183], v[212:227]
  s_waitcnt lgkmcnt(4)
  ds_read_b128 a[200:203], v12 offset:17408
  ds_read_b128 a[204:207], v12 offset:19456
  v_cvt_scalef32_pk_bf16_fp4 v157, v135, 1.0 op_sel:[1,0,0]
  v_cvt_scalef32_pk_bf16_fp4 v158, v135, 1.0 op_sel:[0,1,0]
  v_cvt_scalef32_pk_bf16_fp4 v159, v135, 1.0 op_sel:[1,1,0]
  v_mfma_f32_32x32x16_bf16 v[236:251], v[176:179], a[184:187], v[236:251]
  s_waitcnt vmcnt(12) lgkmcnt(5)
  ds_read_b128 a[216:219], v21 offset:38656
  v_exp_f32 v36, v36
  v_cvt_pk_bf16_f32 v93, v34, v35
  v_cvt_scalef32_pk_bf16_fp4 v160, v136, 1.0 op_sel:[0,0,0]
  v_cvt_scalef32_pk_bf16_fp4 v161, v136, 1.0 op_sel:[1,0,0]
  v_mfma_f32_32x32x16_bf16 v[212:227], v[176:179], a[188:191], v[212:227]
  s_waitcnt lgkmcnt(5)
  ds_read_b128 a[220:223], v21 offset:38752
  v_exp_f32 v37, v37
  v_exp_f32 v38, v38
  v_cvt_scalef32_pk_bf16_fp4 v162, v136, 1.0 op_sel:[0,1,0]
  v_mfma_f32_32x32x16_bf16 v[236:251], v[152:155], a[192:195], v[236:251]
  s_waitcnt vmcnt(7) lgkmcnt(5)
  v_cmp_eq_u32 vcc, s61, v22
  s_cmp_eq_u64 vcc, -1
  s_cbranch_scc0 L_bspin0
L_bok:
  s_mov_b32 s19, 0x58800000
  v_cvt_pk_bf16_f32 v94, v36, v37
  v_mfma_f32_32x32x16_bf16 v[212:227], v[152:155], a[196:199], v[212:227]
  s_waitcnt lgkmcnt(3)
  buffer_load_dwordx4 a[64:67], v3, s[24:27], s46 offen offset:0 sc1
  v_exp_f32 v39, v39
  v_exp_f32 v40, v40
  v_mfma_f32_32x32x16_bf16 v[236:251], v[156:159], a[200:203], v[236:251]
  s_waitcnt lgkmcnt(2)
  buffer_load_dwordx4 a[68:71], v3, s[24:27], s46 offen offset:1024 sc1
  v_cvt_pk_bf16_f32 v95, v38, v39
  v_exp_f32 v41, v41
  v_cvt_scalef32_pk_bf16_fp4 v163, v136, 1.0 op_sel:[1,1,0]
  v_mfma_f32_32x32x16_bf16 v[212:227], v[156:159], a[204:207], v[212:227]
  ds_write_b128 v9, v[92:95] offset:33792
  v_mfma_f32_16x16x32_bf16 v[228:231], a[212:215], v[92:95], v[228:231]
  v_exp_f32 v42, v42
  v_mfma_f32_32x32x16_bf16 v[56:71], a[224:227], a[0:3], v[196:211]
  buffer_load_dwordx4 a[72:75], v3, s[24:27], s46 offen offset:2048 sc1
  v_cvt_pk_bf16_f32 v96, v40, v41
  v_exp_f32 v43, v43
  v_exp_f32 v44, v44
  v_mfma_f32_32x32x16_bf16 v[56:71], a[228:231], a[4:7], v[56:71]
  ds_read_b128 v[180:183], v18 offset:28160
  v_cvt_pk_bf16_f32 v97, v42, v43
  v_exp_f32 v45, v45
  v_exp_f32 v46, v46
  v_mfma_f32_32x32x16_bf16 v[56:71], a[232:235], a[8:11], v[56:71]
  s_waitcnt vmcnt(9)
  ds_read_b128 v[184:187], v18 offset:28192
  buffer_load_dwordx4 a[76:79], v3, s[24:27], s46 offen offset:3072 sc1
  v_cvt_pk_bf16_f32 v98, v44, v45
  v_exp_f32 v47, v47
  v_mfma_f32_32x32x16_bf16 v[56:71], a[236:239], a[12:15], v[56:71]
  s_waitcnt vmcnt(9)
  ds_read_b128 v[188:191], v18 offset:28224
  v_exp_f32 v48, v48
  v_cvt_pk_bf16_f32 v99, v46, v47
  v_cvt_scalef32_pk_bf16_fp4 v164, v137, 1.0 op_sel:[0,0,0]
  v_cvt_scalef32_pk_bf16_fp4 v165, v137, 1.0 op_sel:[1,0,0]
  v_mfma_f32_32x32x16_bf16 v[56:71], a[240:243], a[16:19], v[56:71]
  s_waitcnt vmcnt(8)
  ds_write_b128 v9, v[96:99] offset:34816
  v_mfma_f32_16x16x32_bf16 v[232:235], a[208:211], v[96:99], v[232:235]
  v_exp_f32 v49, v49
  v_mfma_f32_32x32x16_bf16 v[56:71], a[244:247], a[20:23], v[56:71]
  s_waitcnt vmcnt(7)
  buffer_load_dwordx4 a[80:83], v4, s[24:27], s46 offen offset:0 sc1
  v_exp_f32 v50, v50
  v_cvt_pk_bf16_f32 v100, v48, v49
  v_exp_f32 v51, v51
  v_mfma_f32_32x32x16_bf16 v[56:71], a[248:251], a[24:27], v[56:71]
  s_waitcnt vmcnt(7)
  ds_read_b128 v[192:195], v18 offset:28256
  buffer_load_dwordx4 a[84:87], v4, s[24:27], s46 offen offset:1024 sc1
  v_exp_f32 v52, v52
  v_cvt_pk_bf16_f32 v101, v50, v51
  v_mfma_f32_32x32x16_bf16 v[56:71], a[252:255], a[28:31], v[56:71]
  v_exp_f32 v53, v53
  v_exp_f32 v54, v54
  v_cvt_pk_bf16_f32 v102, v52, v53
  v_cvt_scalef32_pk_bf16_fp4 v166, v137, 1.0 op_sel:[0,1,0]
  v_mfma_f32_32x32x16_bf16 v[72:87], a[224:227], a[32:35], v[196:211]
  buffer_load_dwordx4 a[88:91], v4, s[24:27], s46 offen offset:2048 sc1
  v_exp_f32 v55, v55
  s_nop 0
  v_cvt_pk_bf16_f32 v103, v54, v55
  v_cvt_scalef32_pk_bf16_fp4 v167, v137, 1.0 op_sel:[1,1,0]
  v_mfma_f32_32x32x16_bf16 v[72:87], a[228:231], a[36:39], v[72:87]
  ds_write_b128 v9, v[100:103] offset:35840
  v_mfma_f32_16x16x32_bf16 v[232:235], a[212:215], v[100:103], v[232:235]
  v_cvt_scalef32_pk_bf16_fp4 v168, v138, 1.0 op_sel:[0,0,0]
  v_cvt_scalef32_pk_bf16_fp4 v169, v138, 1.0 op_sel:[1,0,0]
  v_mfma_f32_32x32x16_bf16 v[72:87], a[232:235], a[40:43], v[72:87]
  buffer_load_dwordx4 a[92:95], v4, s[24:27], s46 offen offset:3072 sc1
  v_cvt_scalef32_pk_bf16_fp4 v170, v138, 1.0 op_sel:[0,1,0]
  v_cvt_scalef32_pk_bf16_fp4 v171, v138, 1.0 op_sel:[1,1,0]
  v_cvt_scalef32_pk_bf16_fp4 v172, v139, 1.0 op_sel:[0,0,0]
  v_cvt_scalef32_pk_bf16_fp4 v173, v139, 1.0 op_sel:[1,0,0]
  v_mfma_f32_32x32x16_bf16 v[72:87], a[236:239], a[44:47], v[72:87]
  v_exp_f32 v56, v56
  v_cvt_scalef32_pk_bf16_fp4 v174, v139, 1.0 op_sel:[0,1,0]
  v_cvt_scalef32_pk_bf16_fp4 v175, v139, 1.0 op_sel:[1,1,0]
  v_exp_f32 v57, v57
  v_mfma_f32_32x32x16_bf16 v[72:87], a[240:243], a[48:51], v[72:87]
  buffer_load_dwordx4 v[120:123], v5, s[24:27], s46 offen sc1
  v_exp_f32 v58, v58
  v_cvt_pk_bf16_f32 v104, v56, v57
  v_cvt_scalef32_pk_bf16_fp4 v176, v140, 1.0 op_sel:[0,0,0]
  v_mfma_f32_32x32x16_bf16 v[72:87], a[244:247], a[52:55], v[72:87]
  s_waitcnt lgkmcnt(0)
  s_barrier
  ds_read_b128 a[160:163], v10 offset:32768
  v_mfma_f32_32x32x16_bf16 v[72:87], a[248:251], a[56:59], v[72:87]
  ds_read_b128 a[164:167], v10 offset:34816
  buffer_load_dwordx4 v[124:127], v6, s[24:27], s46 offen sc1
  v_cvt_scalef32_pk_bf16_fp4 v177, v140, 1.0 op_sel:[1,0,0]
  v_cvt_scalef32_pk_bf16_fp4 v178, v140, 1.0 op_sel:[0,1,0]
  v_cvt_scalef32_pk_bf16_fp4 v179, v140, 1.0 op_sel:[1,1,0]
  v_mfma_f32_32x32x16_bf16 v[72:87], a[252:255], a[60:63], v[72:87]
  ds_read_b128 a[168:171], v10 offset:33792
  v_exp_f32 v59, v59
  v_exp_f32 v60, v60
  v_cvt_scalef32_pk_bf16_fp4 v152, v141, 1.0 op_sel:[0,0,0]
  v_mfma_f32_32x32x16_bf16 v[236:251], v[160:163], v[88:91], v[236:251]
  ds_read_b128 a[172:175], v10 offset:35840
  buffer_load_dwordx4 a[96:99], v3, s[24:27], s47 offen offset:0 sc1
  v_cvt_pk_bf16_f32 v105, v58, v59
  v_cvt_scalef32_pk_bf16_fp4 v153, v141, 1.0 op_sel:[1,0,0]
  v_cvt_scalef32_pk_bf16_fp4 v154, v141, 1.0 op_sel:[0,1,0]
  v_mfma_f32_32x32x16_bf16 v[212:227], v[160:163], v[96:99], v[212:227]
  ds_read_b128 a[176:179], v11 offset:32768
  v_exp_f32 v61, v61
  v_exp_f32 v62, v62
  v_cvt_scalef32_pk_bf16_fp4 v155, v141, 1.0 op_sel:[1,1,0]
  v_mfma_f32_32x32x16_bf16 v[236:251], v[164:167], v[92:95], v[236:251]
  ds_read_b128 a[180:183], v11 offset:34816
  buffer_load_dwordx4 a[100:103], v3, s[24:27], s47 offen offset:1024 sc1
  v_cvt_pk_bf16_f32 v106, v60, v61
  v_cvt_scalef32_pk_bf16_fp4 v156, v142, 1.0 op_sel:[0,0,0]
  v_cvt_scalef32_pk_bf16_fp4 v157, v142, 1.0 op_sel:[1,0,0]
  v_mfma_f32_32x32x16_bf16 v[212:227], v[164:167], v[100:103], v[212:227]
  s_waitcnt lgkmcnt(5)
  ds_read_b128 a[184:187], v11 offset:33792
  v_exp_f32 v63, v63
  v_exp_f32 v64, v64
  v_cvt_scalef32_pk_bf16_fp4 v158, v142, 1.0 op_sel:[0,1,0]
  v_mfma_f32_32x32x16_bf16 v[236:251], v[168:171], a[160:163], v[236:251]
  s_waitcnt lgkmcnt(5)
  ds_read_b128 a[188:191], v11 offset:35840
  buffer_load_dwordx4 a[104:107], v3, s[24:27], s47 offen offset:2048 sc1
  v_cvt_pk_bf16_f32 v107, v62, v63
  v_cvt_scalef32_pk_bf16_fp4 v159, v142, 1.0 op_sel:[1,1,0]
  v_cvt_scalef32_pk_bf16_fp4 v160, v143, 1.0 op_sel:[0,0,0]
  v_mfma_f32_32x32x16_bf16 v[212:227], v[168:171], a[164:167], v[212:227]
  s_waitcnt lgkmcnt(5)
  ds_write_b128 v9, v[104:107] offset:0
  v_mfma_f32_16x16x32_bf16 v[228:231], a[216:219], v[104:107], v[228:231]
  v_exp_f32 v65, v65
  v_mfma_f32_32x32x16_bf16 v[236:251], v[172:175], a[168:171], v[236:251]
  s_waitcnt lgkmcnt(5)
  buffer_load_dwordx4 a[108:111], v3, s[24:27], s47 offen offset:3072 sc1
  v_exp_f32 v66, v66
  v_cvt_pk_bf16_f32 v108, v64, v65
  v_cvt_scalef32_pk_bf16_fp4 v161, v143, 1.0 op_sel:[1,0,0]
  v_mfma_f32_32x32x16_bf16 v[212:227], v[172:175], a[172:175], v[212:227]
  s_waitcnt lgkmcnt(4)
  ds_read_b128 a[192:195], v12 offset:32768
  ds_read_b128 a[196:199], v12 offset:34816
  v_exp_f32 v67, v67
  v_cvt_scalef32_pk_bf16_fp4 v162, v143, 1.0 op_sel:[0,1,0]
  v_mfma_f32_32x32x16_bf16 v[236:251], v[176:179], a[176:179], v[236:251]
  s_waitcnt lgkmcnt(5)
  ds_read_b128 a[200:203], v12 offset:33792
  buffer_load_dwordx4 a[112:115], v4, s[24:27], s47 offen offset:0 sc1
  v_exp_f32 v68, v68
  v_cvt_scalef32_pk_bf16_fp4 v163, v143, 1.0 op_sel:[1,1,0]
  v_mfma_f32_32x32x16_bf16 v[212:227], v[176:179], a[180:183], v[212:227]
  s_waitcnt vmcnt(16) lgkmcnt(5)
  ds_read_b128 a[204:207], v12 offset:35840
  v_cvt_pk_bf16_f32 v109, v66, v67
  v_exp_f32 v69, v69
  v_cvt_scalef32_pk_bf16_fp4 v164, v144, 1.0 op_sel:[0,0,0]
  v_cvt_scalef32_pk_bf16_fp4 v165, v144, 1.0 op_sel:[1,0,0]
  v_mfma_f32_32x32x16_bf16 v[236:251], v[152:155], a[184:187], v[236:251]
  s_waitcnt lgkmcnt(5)
  ds_read_b128 a[208:211], v252 offset:36352
  v_exp_f32 v70, v70
  v_cvt_pk_bf16_f32 v110, v68, v69
  v_cvt_scalef32_pk_bf16_fp4 v166, v144, 1.0 op_sel:[0,1,0]
  v_cvt_scalef32_pk_bf16_fp4 v167, v144, 1.0 op_sel:[1,1,0]
  v_mfma_f32_32x32x16_bf16 v[212:227], v[152:155], a[188:191], v[212:227]
  s_waitcnt lgkmcnt(4)
  ds_read_b128 a[212:215], v252 offset:36448
  buffer_load_dwordx4 a[116:119], v4, s[24:27], s47 offen offset:1024 sc1
  v_exp_f32 v71, v71
  v_cvt_scalef32_pk_bf16_fp4 v168, v145, 1.0 op_sel:[0,0,0]
  v_mfma_f32_32x32x16_bf16 v[236:251], v[156:159], a[192:195], v[236:251]
  s_waitcnt lgkmcnt(4)
  v_exp_f32 v72, v72
  v_cvt_pk_bf16_f32 v111, v70, v71
  v_exp_f32 v73, v73
  v_cvt_scalef32_pk_bf16_fp4 v169, v145, 1.0 op_sel:[1,0,0]
  v_mfma_f32_32x32x16_bf16 v[212:227], v[156:159], a[196:199], v[212:227]
  s_waitcnt lgkmcnt(3)
  ds_write_b128 v9, v[108:111] offset:1024
  v_mfma_f32_16x16x32_bf16 v[228:231], a[220:223], v[108:111], v[228:231]
  v_exp_f32 v74, v74
  v_mfma_f32_32x32x16_bf16 v[236:251], v[160:163], a[200:203], v[236:251]
  s_waitcnt lgkmcnt(3)
  buffer_load_dwordx4 a[120:123], v4, s[24:27], s47 offen offset:2048 sc1
  v_cvt_pk_bf16_f32 v112, v72, v73
  v_exp_f32 v75, v75
  v_cvt_scalef32_pk_bf16_fp4 v170, v145, 1.0 op_sel:[0,1,0]
  v_mfma_f32_32x32x16_bf16 v[212:227], v[160:163], a[204:207], v[212:227]
  s_waitcnt vmcnt(16)
  buffer_load_dwordx4 a[124:127], v4, s[24:27], s47 offen offset:3072 sc1
  v_exp_f32 v76, v76
  v_cvt_pk_bf16_f32 v113, v74, v75
  v_cvt_scalef32_pk_bf16_fp4 v171, v145, 1.0 op_sel:[1,1,0]
  v_mfma_f32_32x32x16_bf16 v[24:39], a[64:67], a[0:3], v[180:195]
  s_waitcnt vmcnt(16)
  ds_read_b128 v[196:199], v18 offset:28672
  v_exp_f32 v77, v77
  v_exp_f32 v78, v78
  v_cvt_scalef32_pk_bf16_fp4 v172, v146, 1.0 op_sel:[0,0,0]
  v_mfma_f32_32x32x16_bf16 v[24:39], a[68:71], a[4:7], v[24:39]
  s_waitcnt vmcnt(15)
  ds_read_b128 v[200:203], v18 offset:28704
  buffer_load_dwordx4 v[128:131], v5, s[24:27], s47 offen sc1
  v_cvt_pk_bf16_f32 v114, v76, v77
  v_cvt_scalef32_pk_bf16_fp4 v173, v146, 1.0 op_sel:[1,0,0]
  v_cvt_scalef32_pk_bf16_fp4 v174, v146, 1.0 op_sel:[0,1,0]
  v_mfma_f32_32x32x16_bf16 v[24:39], a[72:75], a[8:11], v[24:39]
  s_waitcnt vmcnt(15)
  ds_read_b128 v[204:207], v18 offset:28736
  v_exp_f32 v79, v79
  v_exp_f32 v80, v80
  v_cvt_scalef32_pk_bf16_fp4 v175, v146, 1.0 op_sel:[1,1,0]
  v_mfma_f32_32x32x16_bf16 v[24:39], a[76:79], a[12:15], v[24:39]
  s_waitcnt vmcnt(14)
  ds_read_b128 v[208:211], v18 offset:28768
  buffer_load_dwordx4 v[132:135], v6, s[24:27], s47 offen sc1
  v_cvt_pk_bf16_f32 v115, v78, v79
  v_cvt_scalef32_pk_bf16_fp4 v176, v147, 1.0 op_sel:[0,0,0]
  v_cvt_scalef32_pk_bf16_fp4 v177, v147, 1.0 op_sel:[1,0,0]
  v_mfma_f32_32x32x16_bf16 v[24:39], a[80:83], a[16:19], v[24:39]
  s_waitcnt vmcnt(14)
  ds_write_b128 v9, v[112:115] offset:2048
  v_mfma_f32_16x16x32_bf16 v[232:235], a[216:219], v[112:115], v[232:235]
  v_exp_f32 v81, v81
  v_mfma_f32_32x32x16_bf16 v[24:39], a[84:87], a[20:23], v[24:39]
  s_waitcnt vmcnt(13)
  buffer_load_dwordx4 a[128:131], v3, s[24:27], s48 offen offset:0 sc1
  v_exp_f32 v82, v82
  v_cvt_pk_bf16_f32 v116, v80, v81
  v_exp_f32 v83, v83
  v_mfma_f32_32x32x16_bf16 v[24:39], a[88:91], a[24:27], v[24:39]
  s_waitcnt vmcnt(13)
  v_exp_f32 v84, v84
  v_cvt_pk_bf16_f32 v117, v82, v83
  v_exp_f32 v85, v85
  v_cvt_scalef32_pk_bf16_fp4 v178, v147, 1.0 op_sel:[0,1,0]
  v_mfma_f32_32x32x16_bf16 v[24:39], a[92:95], a[28:31], v[24:39]
  buffer_load_dwordx4 a[132:135], v3, s[24:27], s48 offen offset:1024 sc1
  v_exp_f32 v86, v86
  v_cvt_pk_bf16_f32 v118, v84, v85
  v_cvt_scalef32_pk_bf16_fp4 v179, v147, 1.0 op_sel:[1,1,0]
  v_mfma_f32_32x32x16_bf16 v[40:55], a[64:67], a[32:35], v[180:195]
  v_exp_f32 v87, v87
  s_nop 0
  v_cvt_pk_bf16_f32 v119, v86, v87
  v_cvt_scalef32_pk_bf16_fp4 v152, v148, 1.0 op_sel:[0,0,0]
  v_cvt_scalef32_pk_bf16_fp4 v153, v148, 1.0 op_sel:[1,0,0]
  v_cvt_scalef32_pk_bf16_fp4 v154, v148, 1.0 op_sel:[0,1,0]
  v_mfma_f32_32x32x16_bf16 v[40:55], a[68:71], a[36:39], v[40:55]
  ds_write_b128 v9, v[116:119] offset:3072
  v_mfma_f32_16x16x32_bf16 v[232:235], a[220:223], v[116:119], v[232:235]
  v_cvt_scalef32_pk_bf16_fp4 v155, v148, 1.0 op_sel:[1,1,0]
  v_cvt_scalef32_pk_bf16_fp4 v156, v149, 1.0 op_sel:[0,0,0]
  v_mfma_f32_32x32x16_bf16 v[40:55], a[72:75], a[40:43], v[40:55]
  buffer_load_dwordx4 a[136:139], v3, s[24:27], s48 offen offset:2048 sc1
  v_exp_f32 v24, v24
  v_exp_f32 v25, v25
  v_mfma_f32_32x32x16_bf16 v[40:55], a[76:79], a[44:47], v[40:55]
  buffer_load_dwordx4 a[140:143], v3, s[24:27], s48 offen offset:3072 sc1
  v_exp_f32 v26, v26
  v_cvt_pk_bf16_f32 v88, v24, v25
  v_cvt_scalef32_pk_bf16_fp4 v157, v149, 1.0 op_sel:[1,0,0]
  v_mfma_f32_32x32x16_bf16 v[40:55], a[80:83], a[48:51], v[40:55]
  v_exp_f32 v27, v27
  v_exp_f32 v28, v28
  v_cvt_pk_bf16_f32 v89, v26, v27
  v_cvt_scalef32_pk_bf16_fp4 v158, v149, 1.0 op_sel:[0,1,0]
  v_mfma_f32_32x32x16_bf16 v[40:55], a[84:87], a[52:55], v[40:55]
  s_waitcnt lgkmcnt(0)
  s_barrier
  ds_read_b128 a[160:163], v10 offset:0
  v_mfma_f32_32x32x16_bf16 v[40:55], a[88:91], a[56:59], v[40:55]
  ds_read_b128 a[164:167], v10 offset:2048
  buffer_load_dwordx4 a[144:147], v4, s[24:27], s48 offen offset:0 sc1
  v_exp_f32 v29, v29
  v_cvt_scalef32_pk_bf16_fp4 v159, v149, 1.0 op_sel:[1,1,0]
  v_mfma_f32_32x32x16_bf16 v[40:55], a[92:95], a[60:63], v[40:55]
  ds_read_b128 a[168:171], v10 offset:1024
  buffer_load_dwordx4 a[148:151], v4, s[24:27], s48 offen offset:1024 sc1
  v_exp_f32 v30, v30
  v_cvt_scalef32_pk_bf16_fp4 v160, v150, 1.0 op_sel:[0,0,0]
  v_mfma_f32_32x32x16_bf16 v[236:251], v[164:167], v[104:107], v[236:251]
  ds_read_b128 a[172:175], v10 offset:3072
  v_cvt_pk_bf16_f32 v90, v28, v29
  v_exp_f32 v31, v31
  v_cvt_scalef32_pk_bf16_fp4 v161, v150, 1.0 op_sel:[1,0,0]
  v_cvt_scalef32_pk_bf16_fp4 v162, v150, 1.0 op_sel:[0,1,0]
  v_mfma_f32_32x32x16_bf16 v[212:227], v[164:167], v[112:115], v[212:227]
  ds_read_b128 a[176:179], v11 offset:0
  buffer_load_dwordx4 a[152:155], v4, s[24:27], s48 offen offset:2048 sc1
  v_exp_f32 v32, v32
  v_cvt_scalef32_pk_bf16_fp4 v163, v150, 1.0 op_sel:[1,1,0]
  v_mfma_f32_32x32x16_bf16 v[236:251], v[168:171], v[108:111], v[236:251]
  ds_read_b128 a[180:183], v11 offset:2048
  v_cvt_pk_bf16_f32 v91, v30, v31
  v_exp_f32 v33, v33
  v_cvt_scalef32_pk_bf16_fp4 v164, v151, 1.0 op_sel:[0,0,0]
  v_cvt_scalef32_pk_bf16_fp4 v165, v151, 1.0 op_sel:[1,0,0]
  v_mfma_f32_32x32x16_bf16 v[212:227], v[168:171], v[116:119], v[212:227]
  s_waitcnt lgkmcnt(5)
  ds_write_b128 v9, v[88:91] offset:16384
  v_mfma_f32_16x16x32_bf16 v[228:231], a[208:211], v[88:91], v[228:231]
  v_exp_f32 v34, v34
  v_mfma_f32_32x32x16_bf16 v[236:251], v[172:175], a[160:163], v[236:251]
  s_waitcnt lgkmcnt(5)
  buffer_load_dwordx4 a[156:159], v4, s[24:27], s48 offen offset:3072 sc1
  v_cvt_pk_bf16_f32 v92, v32, v33
  v_exp_f32 v35, v35
  v_cvt_scalef32_pk_bf16_fp4 v166, v151, 1.0 op_sel:[0,1,0]
  v_mfma_f32_32x32x16_bf16 v[212:227], v[172:175], a[164:167], v[212:227]
  s_waitcnt lgkmcnt(4)
  ds_read_b128 a[184:187], v11 offset:1024
  ds_read_b128 a[188:191], v11 offset:3072
  buffer_load_dwordx4 a[224:227], v3, s[24:27], s49 offen offset:0 sc1
  v_cvt_scalef32_pk_bf16_fp4 v167, v151, 1.0 op_sel:[1,1,0]
  v_mfma_f32_32x32x16_bf16 v[236:251], v[176:179], a[168:171], v[236:251]
  s_waitcnt vmcnt(20) lgkmcnt(5)
  ds_read_b128 a[192:195], v12 offset:0
  v_exp_f32 v36, v36
  v_cvt_pk_bf16_f32 v93, v34, v35
  v_cvt_scalef32_pk_bf16_fp4 v168, v120, 1.0 op_sel:[0,0,0]
  v_cvt_scalef32_pk_bf16_fp4 v169, v120, 1.0 op_sel:[1,0,0]
  v_mfma_f32_32x32x16_bf16 v[212:227], v[176:179], a[172:175], v[212:227]
  s_waitcnt lgkmcnt(5)
  ds_read_b128 a[196:199], v12 offset:2048
  v_exp_f32 v37, v37
  v_exp_f32 v38, v38
  v_cvt_scalef32_pk_bf16_fp4 v170, v120, 1.0 op_sel:[0,1,0]
  v_mfma_f32_32x32x16_bf16 v[236:251], v[152:155], a[176:179], v[236:251]
  s_waitcnt lgkmcnt(5)
  ds_read_b128 a[200:203], v12 offset:1024
  buffer_load_dwordx4 a[228:231], v3, s[24:27], s49 offen offset:1024 sc1
  v_cvt_pk_bf16_f32 v94, v36, v37
  v_cvt_scalef32_pk_bf16_fp4 v171, v120, 1.0 op_sel:[1,1,0]
  v_cvt_scalef32_pk_bf16_fp4 v172, v121, 1.0 op_sel:[0,0,0]
  v_mfma_f32_32x32x16_bf16 v[212:227], v[152:155], a[180:183], v[212:227]
  s_waitcnt lgkmcnt(4)
  ds_read_b128 a[204:207], v12 offset:3072
  v_exp_f32 v39, v39
  v_exp_f32 v40, v40
  v_cvt_scalef32_pk_bf16_fp4 v173, v121, 1.0 op_sel:[1,0,0]
  v_mfma_f32_32x32x16_bf16 v[236:251], v[156:159], a[184:187], v[236:251]
  s_waitcnt lgkmcnt(4)
  ds_read_b128 a[216:219], v252 offset:37120
  buffer_load_dwordx4 a[232:235], v3, s[24:27], s49 offen offset:2048 sc1
  v_cvt_pk_bf16_f32 v95, v38, v39
  v_cvt_scalef32_pk_bf16_fp4 v174, v121, 1.0 op_sel:[0,1,0]
  v_cvt_scalef32_pk_bf16_fp4 v175, v121, 1.0 op_sel:[1,1,0]
  v_mfma_f32_32x32x16_bf16 v[212:227], v[156:159], a[188:191], v[212:227]
  s_waitcnt lgkmcnt(4)
  ds_write_b128 v9, v[92:95] offset:17408
  v_mfma_f32_16x16x32_bf16 v[228:231], a[212:215], v[92:95], v[228:231]
  v_exp_f32 v41, v41
  v_mfma_f32_32x32x16_bf16 v[236:251], v[160:163], a[192:195], v[236:251]
  s_waitcnt lgkmcnt(4)
  buffer_load_dwordx4 a[236:239], v3, s[24:27], s49 offen offset:3072 sc1
  v_exp_f32 v42, v42
  v_cvt_pk_bf16_f32 v96, v40, v41
  v_cvt_scalef32_pk_bf16_fp4 v176, v122, 1.0 op_sel:[0,0,0]
  v_mfma_f32_32x32x16_bf16 v[212:227], v[160:163], a[196:199], v[212:227]
  s_waitcnt lgkmcnt(3)
  ds_read_b128 a[220:223], v252 offset:37216
  v_exp_f32 v43, v43
  v_exp_f32 v44, v44
  v_cvt_scalef32_pk_bf16_fp4 v177, v122, 1.0 op_sel:[1,0,0]
  v_mfma_f32_32x32x16_bf16 v[236:251], v[164:167], a[200:203], v[236:251]
  s_waitcnt lgkmcnt(3)
  buffer_load_dwordx4 a[240:243], v4, s[24:27], s49 offen offset:0 sc1
  v_cvt_pk_bf16_f32 v97, v42, v43
  v_exp_f32 v45, v45
  v_cvt_scalef32_pk_bf16_fp4 v178, v122, 1.0 op_sel:[0,1,0]
  v_mfma_f32_32x32x16_bf16 v[212:227], v[164:167], a[204:207], v[212:227]
  s_waitcnt vmcnt(22)
  v_exp_f32 v46, v46
  v_cvt_pk_bf16_f32 v98, v44, v45
  v_exp_f32 v47, v47
  v_cvt_scalef32_pk_bf16_fp4 v179, v122, 1.0 op_sel:[1,1,0]
  v_mfma_f32_32x32x16_bf16 v[56:71], a[96:99], a[0:3], v[196:211]
  s_waitcnt vmcnt(21)
  ds_read_b128 v[180:183], v0 offset:28160
  buffer_load_dwordx4 a[244:247], v4, s[24:27], s49 offen offset:1024 sc1
  v_exp_f32 v48, v48
  v_cvt_scalef32_pk_bf16_fp4 v152, v123, 1.0 op_sel:[0,0,0]
L_hook1:
  s_cbranch_execz L_warmed
  v_mfma_f32_32x32x16_bf16 v[56:71], a[100:103], a[4:7], v[56:71]
  s_waitcnt vmcnt(21)
  ds_read_b128 v[184:187], v0 offset:28192
  v_cvt_pk_bf16_f32 v99, v46, v47
  v_exp_f32 v49, v49
  v_cvt_scalef32_pk_bf16_fp4 v153, v123, 1.0 op_sel:[1,0,0]
  v_cvt_scalef32_pk_bf16_fp4 v154, v123, 1.0 op_sel:[0,1,0]
  v_mfma_f32_32x32x16_bf16 v[56:71], a[104:107], a[8:11], v[56:71]
  s_waitcnt vmcnt(20)
  ds_write_b128 v9, v[96:99] offset:18432
  v_mfma_f32_16x16x32_bf16 v[232:235], a[208:211], v[96:99], v[232:235]
  v_exp_f32 v50, v50
  v_mfma_f32_32x32x16_bf16 v[56:71], a[108:111], a[12:15], v[56:71]
  s_waitcnt vmcnt(19)
  buffer_load_dwordx4 a[248:251], v4, s[24:27], s49 offen offset:2048 sc1
  v_cvt_pk_bf16_f32 v100, v48, v49
  v_exp_f32 v51, v51
  v_cvt_scalef32_pk_bf16_fp4 v155, v123, 1.0 op_sel:[1,1,0]
  v_mfma_f32_32x32x16_bf16 v[56:71], a[112:115], a[16:19], v[56:71]
  s_waitcnt vmcnt(19)
  ds_read_b128 v[188:191], v0 offset:28224
  buffer_load_dwordx4 a[252:255], v4, s[24:27], s49 offen offset:3072 sc1
  v_exp_f32 v52, v52
  v_cvt_scalef32_pk_bf16_fp4 v156, v124, 1.0 op_sel:[0,0,0]
  v_mfma_f32_32x32x16_bf16 v[56:71], a[116:119], a[20:23], v[56:71]
  s_waitcnt vmcnt(19)
  ds_read_b128 v[192:195], v0 offset:28256
  v_cvt_pk_bf16_f32 v101, v50, v51
  v_exp_f32 v53, v53
  v_cvt_scalef32_pk_bf16_fp4 v157, v124, 1.0 op_sel:[1,0,0]
  v_cvt_scalef32_pk_bf16_fp4 v158, v124, 1.0 op_sel:[0,1,0]
  v_mfma_f32_32x32x16_bf16 v[56:71], a[120:123], a[24:27], v[56:71]
  s_waitcnt vmcnt(18)
  buffer_load_dwordx4 v[136:139], v5, s[24:27], s48 offen sc1
  v_exp_f32 v54, v54
  v_cvt_pk_bf16_f32 v102, v52, v53
  v_cvt_scalef32_pk_bf16_fp4 v159, v124, 1.0 op_sel:[1,1,0]
  v_mfma_f32_32x32x16_bf16 v[56:71], a[124:127], a[28:31], v[56:71]
  v_exp_f32 v55, v55
  s_nop 0
  v_cvt_pk_bf16_f32 v103, v54, v55
  v_cvt_scalef32_pk_bf16_fp4 v160, v125, 1.0 op_sel:[0,0,0]
  v_cvt_scalef32_pk_bf16_fp4 v161, v125, 1.0 op_sel:[1,0,0]
  v_cvt_scalef32_pk_bf16_fp4 v162, v125, 1.0 op_sel:[0,1,0]
  v_mfma_f32_32x32x16_bf16 v[72:87], a[96:99], a[32:35], v[196:211]
  ds_write_b128 v9, v[100:103] offset:19456
  v_mfma_f32_16x16x32_bf16 v[232:235], a[212:215], v[100:103], v[232:235]
  v_cvt_scalef32_pk_bf16_fp4 v163, v125, 1.0 op_sel:[1,1,0]
  v_cvt_scalef32_pk_bf16_fp4 v164, v126, 1.0 op_sel:[0,0,0]
  v_mfma_f32_32x32x16_bf16 v[72:87], a[100:103], a[36:39], v[72:87]
  buffer_load_dwordx4 v[144:147], v5, s[24:27], s49 offen sc1
  v_cvt_scalef32_pk_bf16_fp4 v165, v126, 1.0 op_sel:[1,0,0]
  v_cvt_scalef32_pk_bf16_fp4 v166, v126, 1.0 op_sel:[0,1,0]
  v_cvt_scalef32_pk_bf16_fp4 v167, v126, 1.0 op_sel:[1,1,0]
  v_mfma_f32_32x32x16_bf16 v[72:87], a[104:107], a[40:43], v[72:87]
  ds_read_b128 v[196:199], v0 offset:28672
  buffer_load_dwordx4 v[140:143], v6, s[24:27], s48 offen sc1
  v_exp_f32 v56, v56
  v_mfma_f32_32x32x16_bf16 v[72:87], a[108:111], a[44:47], v[72:87]
  ds_read_b128 v[200:203], v0 offset:28704
  v_exp_f32 v57, v57
  v_exp_f32 v58, v58
  v_mfma_f32_32x32x16_bf16 v[72:87], a[112:115], a[48:51], v[72:87]
  ds_read_b128 v[204:207], v0 offset:28736
  v_cvt_pk_bf16_f32 v104, v56, v57
  v_exp_f32 v59, v59
  v_mfma_f32_32x32x16_bf16 v[72:87], a[116:119], a[52:55], v[72:87]
  s_waitcnt lgkmcnt(3)
  s_barrier
  ds_read_b128 a[160:163], v10 offset:16384
  v_mfma_f32_32x32x16_bf16 v[72:87], a[120:123], a[56:59], v[72:87]
  ds_read_b128 a[164:167], v10 offset:18432
  buffer_load_dwordx4 v[148:151], v6, s[24:27], s49 offen sc1
  v_exp_f32 v60, v60
  v_mfma_f32_32x32x16_bf16 v[72:87], a[124:127], a[60:63], v[72:87]
  ds_read_b128 a[168:171], v10 offset:17408
  buffer_load_dwordx4 a[64:67], v3, s[24:27], s50 offen offset:0 sc1
  v_cvt_pk_bf16_f32 v105, v58, v59
  v_mfma_f32_32x32x16_bf16 v[236:251], v[168:171], v[88:91], v[236:251]
  ds_read_b128 a[172:175], v10 offset:19456
  v_exp_f32 v61, v61
  v_exp_f32 v62, v62
  v_mfma_f32_32x32x16_bf16 v[212:227], v[168:171], v[96:99], v[212:227]
  ds_read_b128 a[176:179], v11 offset:16384
  buffer_load_dwordx4 a[68:71], v3, s[24:27], s50 offen offset:1024 sc1
  v_cvt_pk_bf16_f32 v106, v60, v61
  v_cvt_scalef32_pk_bf16_fp4 v168, v127, 1.0 op_sel:[0,0,0]
  v_cvt_scalef32_pk_bf16_fp4 v169, v127, 1.0 op_sel:[1,0,0]
  v_mfma_f32_32x32x16_bf16 v[236:251], v[172:175], v[92:95], v[236:251]
  ds_read_b128 a[180:183], v11 offset:18432
  v_exp_f32 v63, v63
  v_exp_f32 v64, v64
  v_cvt_scalef32_pk_bf16_fp4 v170, v127, 1.0 op_sel:[0,1,0]
  v_mfma_f32_32x32x16_bf16 v[212:227], v[172:175], v[100:103], v[212:227]
  s_waitcnt lgkmcnt(5)
  ds_read_b128 a[184:187], v11 offset:17408
  buffer_load_dwordx4 a[72:75], v3, s[24:27], s50 offen offset:2048 sc1
  v_cvt_pk_bf16_f32 v107, v62, v63
  v_cvt_scalef32_pk_bf16_fp4 v171, v127, 1.0 op_sel:[1,1,0]
  v_mfma_f32_32x32x16_bf16 v[236:251], v[176:179], a[160:163], v[236:251]
  s_waitcnt lgkmcnt(5)
  ds_write_b128 v9, v[104:107] offset:32768
  v_mfma_f32_16x16x32_bf16 v[228:231], a[216:219], v[104:107], v[228:231]
  v_exp_f32 v65, v65
  v_mfma_f32_32x32x16_bf16 v[212:227], v[176:179], a[164:167], v[212:227]
  s_waitcnt lgkmcnt(5)
  buffer_load_dwordx4 a[76:79], v3, s[24:27], s50 offen offset:3072 sc1
  v_exp_f32 v66, v66
  v_cvt_pk_bf16_f32 v108, v64, v65
  v_mfma_f32_32x32x16_bf16 v[236:251], v[152:155], a[168:171], v[236:251]
  s_waitcnt vmcnt(25) lgkmcnt(4)
  ds_read_b128 a[188:191], v11 offset:19456
  ds_read_b128 a[192:195], v12 offset:16384
  v_exp_f32 v67, v67
  v_cvt_scalef32_pk_bf16_fp4 v172, v128, 1.0 op_sel:[0,0,0]
  v_mfma_f32_32x32x16_bf16 v[212:227], v[152:155], a[172:175], v[212:227]
  s_waitcnt lgkmcnt(5)
  ds_read_b128 a[196:199], v12 offset:18432
  v_exp_f32 v68, v68
  v_cvt_pk_bf16_f32 v109, v66, v67
  v_cvt_scalef32_pk_bf16_fp4 v173, v128, 1.0 op_sel:[1,0,0]
  v_cvt_scalef32_pk_bf16_fp4 v174, v128, 1.0 op_sel:[0,1,0]
  v_mfma_f32_32x32x16_bf16 v[236:251], v[156:159], a[176:179], v[236:251]
  s_waitcnt lgkmcnt(5)
  ds_read_b128 a[200:203], v12 offset:17408
  buffer_load_dwordx4 a[80:83], v4, s[24:27], s50 offen offset:0 sc1
  v_exp_f32 v69, v69
  v_cvt_scalef32_pk_bf16_fp4 v175, v128, 1.0 op_sel:[1,1,0]
  v_mfma_f32_32x32x16_bf16 v[212:227], v[156:159], a[180:183], v[212:227]
  s_waitcnt lgkmcnt(5)
  ds_read_b128 a[204:207], v12 offset:19456
  v_exp_f32 v70, v70
  v_cvt_pk_bf16_f32 v110, v68, v69
  v_cvt_scalef32_pk_bf16_fp4 v176, v129, 1.0 op_sel:[0,0,0]
  v_cvt_scalef32_pk_bf16_fp4 v177, v129, 1.0 op_sel:[1,0,0]
  v_mfma_f32_32x32x16_bf16 v[236:251], v[160:163], a[184:187], v[236:251]
  s_waitcnt lgkmcnt(4)
  ds_read_b128 v[208:211], v0 offset:28768
  buffer_load_dwordx4 a[84:87], v4, s[24:27], s50 offen offset:1024 sc1
  v_exp_f32 v71, v71
  v_cvt_scalef32_pk_bf16_fp4 v178, v129, 1.0 op_sel:[0,1,0]
  v_mfma_f32_32x32x16_bf16 v[212:227], v[160:163], a[188:191], v[212:227]
  s_waitcnt lgkmcnt(4)
  ds_read_b128 a[208:211], v253 offset:36352
  v_exp_f32 v72, v72
  v_cvt_pk_bf16_f32 v111, v70, v71
  v_cvt_scalef32_pk_bf16_fp4 v179, v129, 1.0 op_sel:[1,1,0]
  v_cvt_scalef32_pk_bf16_fp4 v152, v130, 1.0 op_sel:[0,0,0]
  v_mfma_f32_32x32x16_bf16 v[236:251], v[164:167], a[192:195], v[236:251]
  s_waitcnt lgkmcnt(4)
  ds_write_b128 v9, v[108:111] offset:33792
  v_mfma_f32_16x16x32_bf16 v[228:231], a[220:223], v[108:111], v[228:231]
  v_exp_f32 v73, v73
  v_mfma_f32_32x32x16_bf16 v[212:227], v[164:167], a[196:199], v[212:227]
  s_waitcnt lgkmcnt(4)
  buffer_load_dwordx4 a[88:91], v4, s[24:27], s50 offen offset:2048 sc1
  v_exp_f32 v74, v74
  v_cvt_pk_bf16_f32 v112, v72, v73
  v_exp_f32 v75, v75
  v_mfma_f32_32x32x16_bf16 v[236:251], v[168:171], a[200:203], v[236:251]
  s_waitcnt lgkmcnt(3)
  ds_read_b128 a[212:215], v253 offset:36448
  buffer_load_dwordx4 v[120:123], v5, s[24:27], s50 offen sc1
  v_exp_f32 v76, v76
  v_cvt_pk_bf16_f32 v113, v74, v75
  v_mfma_f32_32x32x16_bf16 v[212:227], v[168:171], a[204:207], v[212:227]
  s_waitcnt vmcnt(27)
  v_exp_f32 v77, v77
  v_exp_f32 v78, v78
  v_cvt_pk_bf16_f32 v114, v76, v77
  v_cvt_scalef32_pk_bf16_fp4 v153, v130, 1.0 op_sel:[1,0,0]
  v_mfma_f32_32x32x16_bf16 v[24:39], a[128:131], a[0:3], v[180:195]
  s_waitcnt vmcnt(26)
  buffer_load_dwordx4 a[92:95], v4, s[24:27], s50 offen offset:3072 sc1
  v_exp_f32 v79, v79
  v_exp_f32 v80, v80
  v_mfma_f32_32x32x16_bf16 v[24:39], a[132:135], a[4:7], v[24:39]
  s_waitcnt vmcnt(26)
  v_cvt_pk_bf16_f32 v115, v78, v79
  v_exp_f32 v81, v81
  v_exp_f32 v82, v82
  v_cvt_pk_bf16_f32 v116, v80, v81
  v_mfma_f32_32x32x16_bf16 v[24:39], a[136:139], a[8:11], v[24:39]
  s_waitcnt vmcnt(25)
  ds_write_b128 v9, v[112:115] offset:34816
  v_mfma_f32_16x16x32_bf16 v[232:235], a[216:219], v[112:115], v[232:235]
  v_exp_f32 v83, v83
  v_mfma_f32_32x32x16_bf16 v[24:39], a[140:143], a[12:15], v[24:39]
  s_waitcnt vmcnt(24)
  buffer_load_dwordx4 a[96:99], v3, s[24:27], s51 offen offset:0 sc1
  v_exp_f32 v84, v84
  v_cvt_pk_bf16_f32 v117, v82, v83
  v_cvt_scalef32_pk_bf16_fp4 v154, v130, 1.0 op_sel:[0,1,0]
  v_mfma_f32_32x32x16_bf16 v[24:39], a[144:147], a[16:19], v[24:39]
  s_waitcnt vmcnt(24)
  ds_read_b128 a[216:219], v253 offset:37120
  buffer_load_dwordx4 a[100:103], v3, s[24:27], s51 offen offset:1024 sc1
  v_exp_f32 v85, v85
  v_cvt_scalef32_pk_bf16_fp4 v155, v130, 1.0 op_sel:[1,1,0]
  v_mfma_f32_32x32x16_bf16 v[24:39], a[148:151], a[20:23], v[24:39]
  s_waitcnt vmcnt(24)
  ds_read_b128 v[180:183], v0 offset:29184
  v_exp_f32 v86, v86
  v_cvt_pk_bf16_f32 v118, v84, v85
  v_cvt_scalef32_pk_bf16_fp4 v156, v131, 1.0 op_sel:[0,0,0]
  v_cvt_scalef32_pk_bf16_fp4 v157, v131, 1.0 op_sel:[1,0,0]
  v_mfma_f32_32x32x16_bf16 v[24:39], a[152:155], a[24:27], v[24:39]
  s_waitcnt vmcnt(23)
  ds_read_b128 v[184:187], v0 offset:29216
  buffer_load_dwordx4 a[104:107], v3, s[24:27], s51 offen offset:2048 sc1
  v_exp_f32 v87, v87
  s_nop 0
  v_cvt_pk_bf16_f32 v119, v86, v87
  v_mfma_f32_32x32x16_bf16 v[24:39], a[156:159], a[28:31], v[24:39]
  s_waitcnt vmcnt(23) lgkmcnt(7)
  ds_write_b128 v9, v[116:119] offset:35840
  v_mfma_f32_16x16x32_bf16 v[232:235], a[220:223], v[116:119], v[232:235]
  v_cvt_scalef32_pk_bf16_fp4 v158, v131, 1.0 op_sel:[0,1,0]
  v_cvt_scalef32_pk_bf16_fp4 v159, v131, 1.0 op_sel:[1,1,0]
  v_mfma_f32_32x32x16_bf16 v[40:55], a[224:227], a[0:3], v[196:211]
  s_waitcnt vmcnt(22)
  s_nop 3
  ds_write_b64 v14, v[232:233] offset:1024
  ds_write_b64 v14, v[234:235] offset:1536
  buffer_load_dwordx4 v[128:131], v5, s[24:27], s51 offen sc1
  v_mfma_f32_32x32x16_bf16 v[40:55], a[228:231], a[4:7], v[40:55]
  s_waitcnt vmcnt(22)
  ds_read_b128 a[220:223], v253 offset:37216
  v_cvt_scalef32_pk_bf16_fp4 v160, v132, 1.0 op_sel:[0,0,0]
  v_cvt_scalef32_pk_bf16_fp4 v161, v132, 1.0 op_sel:[1,0,0]
  v_cvt_scalef32_pk_bf16_fp4 v162, v132, 1.0 op_sel:[0,1,0]
  v_cvt_scalef32_pk_bf16_fp4 v163, v132, 1.0 op_sel:[1,1,0]
  v_cvt_scalef32_pk_bf16_fp4 v164, v133, 1.0 op_sel:[0,0,0]
  v_mfma_f32_32x32x16_bf16 v[40:55], a[232:235], a[8:11], v[40:55]
  s_waitcnt vmcnt(21)
  ds_read_b128 v[188:191], v0 offset:29248
  buffer_load_dwordx4 a[108:111], v3, s[24:27], s51 offen offset:3072 sc1
  v_exp_f32 v24, v24
  v_cvt_scalef32_pk_bf16_fp4 v165, v133, 1.0 op_sel:[1,0,0]
  v_mfma_f32_32x32x16_bf16 v[40:55], a[236:239], a[12:15], v[40:55]
  s_waitcnt vmcnt(21)
  ds_read_b128 v[192:195], v0 offset:29280
  v_exp_f32 v25, v25
  v_cvt_scalef32_pk_bf16_fp4 v166, v133, 1.0 op_sel:[0,1,0]
  v_cvt_scalef32_pk_bf16_fp4 v167, v133, 1.0 op_sel:[1,1,0]
  v_cvt_scalef32_pk_bf16_fp4 v168, v134, 1.0 op_sel:[0,0,0]
  v_mfma_f32_32x32x16_bf16 v[40:55], a[240:243], a[16:19], v[40:55]
  s_waitcnt vmcnt(20)
  buffer_load_dwordx4 a[112:115], v4, s[24:27], s51 offen offset:0 sc1
  v_exp_f32 v26, v26
  v_cvt_pk_bf16_f32 v88, v24, v25
  v_cvt_scalef32_pk_bf16_fp4 v169, v134, 1.0 op_sel:[1,0,0]
  v_mfma_f32_32x32x16_bf16 v[40:55], a[244:247], a[20:23], v[40:55]
  s_waitcnt vmcnt(20) lgkmcnt(3)
  s_barrier
  ds_read_b128 v[64:67], v15 offset:10240
  ds_read_b128 v[68:71], v15 offset:10256
  ds_read_b128 a[164:167], v10 offset:34816
  v_mfma_f32_32x32x16_bf16 v[40:55], a[248:251], a[24:27], v[40:55]
  s_waitcnt vmcnt(19)
  ds_read_b128 a[172:175], v10 offset:35840
  buffer_load_dwordx4 a[116:119], v4, s[24:27], s51 offen offset:1024 sc1
  v_exp_f32 v27, v27
  v_cvt_scalef32_pk_bf16_fp4 v170, v134, 1.0 op_sel:[0,1,0]
  v_mfma_f32_32x32x16_bf16 v[40:55], a[252:255], a[28:31], v[40:55]
  ds_read_b128 a[180:183], v11 offset:34816
  v_cvt_scalef32_pk_bf16_fp4 v171, v134, 1.0 op_sel:[1,1,0]
  v_exp_f32 v28, v28
  v_cvt_pk_bf16_f32 v89, v26, v27
  v_mfma_f32_32x32x16_bf16 v[212:227], v[172:175], v[112:115], v[212:227]
  ds_read_b128 a[188:191], v11 offset:35840
  buffer_load_dwordx4 a[120:123], v4, s[24:27], s51 offen offset:2048 sc1
  v_exp_f32 v29, v29
  v_mfma_f32_32x32x16_bf16 v[236:251], v[172:175], v[104:107], v[236:251]
  ds_read_b128 a[196:199], v12 offset:34816
  v_cvt_scalef32_pk_bf16_fp4 v172, v135, 1.0 op_sel:[0,0,0]
  v_cvt_scalef32_pk_bf16_fp4 v173, v135, 1.0 op_sel:[1,0,0]
  v_cvt_scalef32_pk_bf16_fp4 v174, v135, 1.0 op_sel:[0,1,0]
  v_cvt_scalef32_pk_bf16_fp4 v175, v135, 1.0 op_sel:[1,1,0]
  v_mfma_f32_32x32x16_bf16 v[212:227], v[176:179], v[116:119], v[212:227]
  ds_read_b128 a[204:207], v12 offset:35840
  buffer_load_dwordx4 v[124:127], v6, s[24:27], s50 offen sc1
  v_exp_f32 v30, v30
  v_mfma_f32_32x32x16_bf16 v[236:251], v[176:179], v[108:111], v[236:251]
  s_waitcnt lgkmcnt(5)
  ds_read_b128 a[160:163], v10 offset:32768
  v_cvt_pk_bf16_f32 v90, v28, v29
  v_exp_f32 v31, v31
  v_mfma_f32_32x32x16_bf16 v[212:227], v[152:155], a[164:167], v[212:227]
  s_waitcnt lgkmcnt(5)
  ds_read_b128 a[168:171], v10 offset:33792
  buffer_load_dwordx4 a[124:127], v4, s[24:27], s51 offen offset:3072 sc1
  v_add_f32 v64, v64, v65
  v_add_f32 v66, v66, v67
  v_add_f32 v68, v68, v69
  v_mfma_f32_32x32x16_bf16 v[212:227], v[156:159], a[172:175], v[212:227]
  s_waitcnt lgkmcnt(5)
  ds_read_b128 a[176:179], v11 offset:32768
  v_add_f32 v70, v70, v71
  v_add_f32 v64, v64, v66
  v_add_f32 v68, v68, v70
  v_add_f32 v114, v64, v68
  v_mov_b32 v107, s61
  v_mfma_f32_32x32x16_bf16 v[212:227], v[160:163], a[180:183], v[212:227]
  s_waitcnt vmcnt(22) lgkmcnt(5)
  ds_read_b128 a[184:187], v11 offset:33792
  v_mov_b32 v111, s61
  v_mov_b32 v115, s61
  v_exp_f32 v32, v32
  v_cvt_scalef32_pk_bf16_fp4 v176, v136, 1.0 op_sel:[0,0,0]
  v_mfma_f32_32x32x16_bf16 v[212:227], v[164:167], a[188:191], v[212:227]
  s_waitcnt lgkmcnt(5)
  ds_read_b128 a[192:195], v12 offset:32768
  buffer_load_dwordx4 v[132:135], v6, s[24:27], s51 offen sc1
  v_cvt_pk_bf16_f32 v91, v30, v31
  v_cvt_scalef32_pk_bf16_fp4 v177, v136, 1.0 op_sel:[1,0,0]
  v_cvt_scalef32_pk_bf16_fp4 v178, v136, 1.0 op_sel:[0,1,0]
  v_mfma_f32_32x32x16_bf16 v[212:227], v[168:171], a[196:199], v[212:227]
  s_waitcnt lgkmcnt(5)
  ds_write_b128 v9, v[88:91] offset:0
  v_mfma_f32_16x16x32_bf16 v[228:231], a[208:211], v[88:91], v[228:231]
  v_exp_f32 v33, v33
  v_mfma_f32_32x32x16_bf16 v[212:227], v[172:175], a[204:207], v[212:227]
  s_waitcnt lgkmcnt(5)
  v_exp_f32 v34, v34
  v_cvt_pk_bf16_f32 v92, v32, v33
  v_exp_f32 v35, v35
  v_cvt_scalef32_pk_bf16_fp4 v179, v136, 1.0 op_sel:[1,1,0]
  v_mfma_f32_32x32x16_bf16 v[236:251], v[152:155], a[160:163], v[236:251]
  s_waitcnt vmcnt(22) lgkmcnt(4)
  ds_read_b128 a[200:203], v12 offset:33792
  v_exp_f32 v36, v36
  v_cvt_pk_bf16_f32 v93, v34, v35
  v_cvt_scalef32_pk_bf16_fp4 v152, v144, 1.0 op_sel:[0,0,0]
  v_cvt_scalef32_pk_bf16_fp4 v153, v144, 1.0 op_sel:[1,0,0]
  v_mfma_f32_32x32x16_bf16 v[236:251], v[156:159], a[168:171], v[236:251]
  s_waitcnt lgkmcnt(4)
  ds_read_b128 v[196:199], v0 offset:29696
  v_exp_f32 v37, v37
  v_exp_f32 v38, v38
  v_cvt_scalef32_pk_bf16_fp4 v154, v144, 1.0 op_sel:[0,1,0]
  v_mfma_f32_32x32x16_bf16 v[236:251], v[160:163], a[176:179], v[236:251]
  s_waitcnt lgkmcnt(4)
  ds_read_b128 v[200:203], v0 offset:29728
  v_cvt_pk_bf16_f32 v104, v212, v213
  v_cvt_pk_bf16_f32 v105, v214, v215
  v_cvt_pk_bf16_f32 v106, v216, v217
  v_cvt_pk_bf16_f32 v112, v218, v219
  v_cvt_pk_bf16_f32 v108, v220, v221
  v_mfma_f32_32x32x16_bf16 v[236:251], v[164:167], a[184:187], v[236:251]
  s_waitcnt lgkmcnt(4)
  ds_read_b128 v[204:207], v0 offset:29760
  buffer_store_dwordx4 v[104:107], v17, s[24:27], s54 offen offset:0 sc1
  v_cvt_pk_bf16_f32 v109, v222, v223
  v_mfma_f32_32x32x16_bf16 v[236:251], v[168:171], a[192:195], v[236:251]
  s_waitcnt lgkmcnt(3)
  ds_read_b128 v[208:211], v0 offset:29792
  v_cvt_pk_bf16_f32 v94, v36, v37
  v_cvt_pk_bf16_f32 v110, v224, v225
  v_cvt_pk_bf16_f32 v113, v226, v227
  v_exp_f32 v39, v39
  v_mfma_f32_32x32x16_bf16 v[236:251], v[172:175], a[200:203], v[236:251]
  s_waitcnt vmcnt(20)
  ds_read_b128 a[208:211], v253 offset:37888
  buffer_store_dwordx4 v[108:111], v17, s[24:27], s54 offen offset:1024 sc1
  v_exp_f32 v40, v40
  v_cvt_pk_bf16_f32 v95, v38, v39
  v_mfma_f32_32x32x16_bf16 v[56:71], a[64:67], a[0:3], v[180:195]
  s_waitcnt vmcnt(20)
  ds_write_b128 v9, v[92:95] offset:1024
  v_exp_f32 v41, v41
  v_mfma_f32_16x16x32_bf16 v[228:231], a[212:215], v[92:95], v[228:231]
  v_exp_f32 v42, v42
  v_mfma_f32_32x32x16_bf16 v[56:71], a[68:71], a[4:7], v[56:71]
  s_waitcnt vmcnt(19)
  buffer_store_dwordx4 v[112:115], v17, s[24:27], s54 offen offset:2048 sc1
  v_cvt_pk_bf16_f32 v96, v40, v41
  v_exp_f32 v43, v43
  v_mfma_f32_32x32x16_bf16 v[56:71], a[72:75], a[8:11], v[56:71]
  s_waitcnt vmcnt(19)
  ds_read_b128 a[212:215], v253 offset:37984
  v_exp_f32 v44, v44
  v_cvt_pk_bf16_f32 v97, v42, v43
  v_exp_f32 v45, v45
  v_mfma_f32_32x32x16_bf16 v[56:71], a[76:79], a[12:15], v[56:71]
  s_waitcnt vmcnt(18)
  v_exp_f32 v46, v46
  v_cvt_pk_bf16_f32 v98, v44, v45
  v_exp_f32 v47, v47
  v_exp_f32 v48, v48
  v_mfma_f32_32x32x16_bf16 v[56:71], a[80:83], a[16:19], v[56:71]
  s_waitcnt vmcnt(17)
  v_cvt_pk_bf16_f32 v99, v46, v47
  v_exp_f32 v49, v49
  v_exp_f32 v50, v50
  v_cvt_pk_bf16_f32 v100, v48, v49
  v_mfma_f32_32x32x16_bf16 v[56:71], a[84:87], a[20:23], v[56:71]
  s_waitcnt vmcnt(16)
  ds_write_b128 v9, v[96:99] offset:2048
  v_mfma_f32_16x16x32_bf16 v[228:231], a[216:219], v[96:99], v[228:231]
  v_exp_f32 v51, v51
  v_mfma_f32_32x32x16_bf16 v[56:71], a[88:91], a[24:27], v[56:71]
  s_waitcnt vmcnt(14)
  v_exp_f32 v52, v52
  v_cvt_pk_bf16_f32 v101, v50, v51
  v_exp_f32 v53, v53
  v_cvt_scalef32_pk_bf16_fp4 v155, v144, 1.0 op_sel:[1,1,0]
  v_mfma_f32_32x32x16_bf16 v[56:71], a[92:95], a[28:31], v[56:71]
  s_waitcnt vmcnt(13) lgkmcnt(4)
  ds_read_b128 a[216:219], v253 offset:38656
  v_exp_f32 v54, v54
  v_cvt_pk_bf16_f32 v102, v52, v53
  v_cvt_scalef32_pk_bf16_fp4 v156, v137, 1.0 op_sel:[0,0,0]
  v_cvt_scalef32_pk_bf16_fp4 v157, v137, 1.0 op_sel:[1,0,0]
  v_mfma_f32_32x32x16_bf16 v[72:87], a[96:99], a[0:3], v[196:211]
  s_waitcnt vmcnt(12)
  v_exp_f32 v55, v55
  s_nop 0
  v_cvt_pk_bf16_f32 v103, v54, v55
  v_cvt_scalef32_pk_bf16_fp4 v158, v137, 1.0 op_sel:[0,1,0]
  v_cvt_scalef32_pk_bf16_fp4 v159, v137, 1.0 op_sel:[1,1,0]
  v_cvt_scalef32_pk_bf16_fp4 v160, v145, 1.0 op_sel:[0,0,0]
  v_mfma_f32_32x32x16_bf16 v[72:87], a[100:103], a[4:7], v[72:87]
  s_waitcnt vmcnt(11)
  ds_write_b128 v9, v[100:103] offset:3072
  v_mfma_f32_16x16x32_bf16 v[228:231], a[220:223], v[100:103], v[228:231]
  v_cvt_scalef32_pk_bf16_fp4 v161, v145, 1.0 op_sel:[1,0,0]
  v_cvt_scalef32_pk_bf16_fp4 v162, v145, 1.0 op_sel:[0,1,0]
  v_mfma_f32_32x32x16_bf16 v[72:87], a[104:107], a[8:11], v[72:87]
  s_waitcnt vmcnt(9)
  v_exp_f32 v56, v56
  v_exp_f32 v57, v57
  v_exp_f32 v58, v58
  v_mfma_f32_32x32x16_bf16 v[72:87], a[108:111], a[12:15], v[72:87]
  s_waitcnt vmcnt(8)
  ds_read_b128 a[220:223], v253 offset:38752
  v_cvt_pk_bf16_f32 v104, v56, v57
  v_exp_f32 v59, v59
  v_exp_f32 v60, v60
  v_mfma_f32_32x32x16_bf16 v[72:87], a[112:115], a[16:19], v[72:87]
  s_waitcnt vmcnt(7)
  v_cvt_pk_bf16_f32 v105, v58, v59
  v_exp_f32 v61, v61
  v_exp_f32 v62, v62
  v_cvt_pk_bf16_f32 v106, v60, v61
  v_mfma_f32_32x32x16_bf16 v[72:87], a[116:119], a[20:23], v[72:87]
  s_waitcnt vmcnt(6) lgkmcnt(1)
  s_barrier
  ds_read_b128 a[160:163], v10 offset:0
  v_mfma_f32_32x32x16_bf16 v[72:87], a[120:123], a[24:27], v[72:87]
  s_waitcnt vmcnt(4)
  ds_read_b128 a[164:167], v10 offset:2048
  v_exp_f32 v63, v63
  v_exp_f32 v64, v64
  v_cvt_pk_bf16_f32 v107, v62, v63
  v_mfma_f32_32x32x16_bf16 v[72:87], a[124:127], a[28:31], v[72:87]
  ds_write_b128 v9, v[104:107] offset:16384
  v_exp_f32 v65, v65
  v_exp_f32 v66, v66
  v_cvt_pk_bf16_f32 v108, v64, v65
  v_mfma_f32_16x16x32_bf16 v[228:231], a[208:211], v[104:107], v[228:231]
  v_exp_f32 v67, v67
  v_mfma_f32_32x32x16_bf16 v[236:251], v[176:179], v[88:91], v[236:251]
  v_exp_f32 v68, v68
  v_cvt_pk_bf16_f32 v109, v66, v67
  v_exp_f32 v69, v69
  v_exp_f32 v70, v70
  v_mfma_f32_32x32x16_bf16 v[236:251], v[152:155], v[96:99], v[236:251]
  ds_read_b128 a[168:171], v10 offset:1024
  ds_read_b128 a[172:175], v10 offset:3072
  v_cvt_pk_bf16_f32 v110, v68, v69
  v_cvt_scalef32_pk_bf16_fp4 v163, v145, 1.0 op_sel:[1,1,0]
  v_cvt_scalef32_pk_bf16_fp4 v164, v138, 1.0 op_sel:[0,0,0]
  v_mfma_f32_32x32x16_bf16 v[236:251], v[156:159], v[92:95], v[236:251]
  ds_read_b128 a[176:179], v11 offset:0
  v_exp_f32 v71, v71
  v_cvt_scalef32_pk_bf16_fp4 v165, v138, 1.0 op_sel:[1,0,0]
  v_exp_f32 v72, v72
  v_cvt_pk_bf16_f32 v111, v70, v71
  v_cvt_scalef32_pk_bf16_fp4 v166, v138, 1.0 op_sel:[0,1,0]
  v_cvt_scalef32_pk_bf16_fp4 v167, v138, 1.0 op_sel:[1,1,0]
  v_mfma_f32_32x32x16_bf16 v[236:251], v[160:163], v[100:103], v[236:251]
  s_waitcnt lgkmcnt(5)
  ds_read_b128 a[180:183], v11 offset:2048
  ds_write_b128 v9, v[108:111] offset:17408
  v_exp_f32 v73, v73
  v_cvt_scalef32_pk_bf16_fp4 v168, v146, 1.0 op_sel:[0,0,0]
  v_cvt_scalef32_pk_bf16_fp4 v169, v146, 1.0 op_sel:[1,0,0]
  v_exp_f32 v74, v74
  v_cvt_pk_bf16_f32 v112, v72, v73
  v_cvt_scalef32_pk_bf16_fp4 v170, v146, 1.0 op_sel:[0,1,0]
  v_cvt_scalef32_pk_bf16_fp4 v171, v146, 1.0 op_sel:[1,1,0]
  v_mfma_f32_16x16x32_bf16 v[228:231], a[212:215], v[108:111], v[228:231]
  v_exp_f32 v75, v75
  v_mfma_f32_32x32x16_bf16 v[236:251], v[164:167], a[160:163], v[236:251]
  s_waitcnt lgkmcnt(6)
  v_cvt_scalef32_pk_bf16_fp4 v172, v139, 1.0 op_sel:[0,0,0]
  v_cvt_scalef32_pk_bf16_fp4 v173, v139, 1.0 op_sel:[1,0,0]
  v_exp_f32 v76, v76
  v_cvt_pk_bf16_f32 v113, v74, v75
  v_cvt_scalef32_pk_bf16_fp4 v174, v139, 1.0 op_sel:[0,1,0]
  v_exp_f32 v77, v77
  v_cvt_scalef32_pk_bf16_fp4 v175, v139, 1.0 op_sel:[1,1,0]
  v_mfma_f32_32x32x16_bf16 v[236:251], v[168:171], a[164:167], v[236:251]
  s_waitcnt lgkmcnt(4)
  ds_read_b128 a[184:187], v11 offset:1024
  ds_read_b128 a[188:191], v11 offset:3072
  v_cvt_scalef32_pk_bf16_fp4 v176, v147, 1.0 op_sel:[0,0,0]
  v_exp_f32 v78, v78
  v_cvt_pk_bf16_f32 v114, v76, v77
  v_cvt_scalef32_pk_bf16_fp4 v177, v147, 1.0 op_sel:[1,0,0]
  v_cvt_scalef32_pk_bf16_fp4 v178, v147, 1.0 op_sel:[0,1,0]
  v_exp_f32 v79, v79
  v_cvt_scalef32_pk_bf16_fp4 v179, v147, 1.0 op_sel:[1,1,0]
  v_mfma_f32_32x32x16_bf16 v[236:251], v[172:175], a[168:171], v[236:251]
  s_waitcnt lgkmcnt(5)
  ds_read_b128 a[192:195], v12 offset:0
  v_cvt_scalef32_pk_bf16_fp4 v152, v140, 1.0 op_sel:[0,0,0]
  v_exp_f32 v80, v80
  v_cvt_pk_bf16_f32 v115, v78, v79
  v_cvt_scalef32_pk_bf16_fp4 v153, v140, 1.0 op_sel:[1,0,0]
  v_cvt_scalef32_pk_bf16_fp4 v154, v140, 1.0 op_sel:[0,1,0]
  v_exp_f32 v81, v81
  v_cvt_scalef32_pk_bf16_fp4 v155, v140, 1.0 op_sel:[1,1,0]
  v_mfma_f32_32x32x16_bf16 v[236:251], v[176:179], a[172:175], v[236:251]
  s_waitcnt lgkmcnt(5)
  ds_read_b128 a[196:199], v12 offset:2048
  ds_write_b128 v9, v[112:115] offset:18432
  v_cvt_scalef32_pk_bf16_fp4 v156, v148, 1.0 op_sel:[0,0,0]
  v_exp_f32 v82, v82
  v_cvt_pk_bf16_f32 v116, v80, v81
  v_cvt_scalef32_pk_bf16_fp4 v157, v148, 1.0 op_sel:[1,0,0]
  v_exp_f32 v83, v83
  v_cvt_scalef32_pk_bf16_fp4 v158, v148, 1.0 op_sel:[0,1,0]
  v_cvt_scalef32_pk_bf16_fp4 v159, v148, 1.0 op_sel:[1,1,0]
  v_mfma_f32_16x16x32_bf16 v[228:231], a[216:219], v[112:115], v[228:231]
  v_exp_f32 v84, v84
  v_mfma_f32_32x32x16_bf16 v[236:251], v[152:155], a[176:179], v[236:251]
  s_waitcnt lgkmcnt(6)
  v_cvt_pk_bf16_f32 v117, v82, v83
  v_cvt_scalef32_pk_bf16_fp4 v160, v141, 1.0 op_sel:[0,0,0]
  v_cvt_scalef32_pk_bf16_fp4 v161, v141, 1.0 op_sel:[1,0,0]
  v_exp_f32 v85, v85
  v_cvt_scalef32_pk_bf16_fp4 v162, v141, 1.0 op_sel:[0,1,0]
  v_cvt_scalef32_pk_bf16_fp4 v163, v141, 1.0 op_sel:[1,1,0]
  v_mfma_f32_32x32x16_bf16 v[236:251], v[156:159], a[180:183], v[236:251]
  s_waitcnt lgkmcnt(4)
  ds_read_b128 a[200:203], v12 offset:1024
  ds_read_b128 a[204:207], v12 offset:3072
  v_exp_f32 v86, v86
  v_cvt_pk_bf16_f32 v118, v84, v85
  v_cvt_scalef32_pk_bf16_fp4 v164, v149, 1.0 op_sel:[0,0,0]
  v_cvt_scalef32_pk_bf16_fp4 v165, v149, 1.0 op_sel:[1,0,0]
  v_exp_f32 v87, v87
  v_cvt_scalef32_pk_bf16_fp4 v166, v149, 1.0 op_sel:[0,1,0]
  v_cvt_pk_bf16_f32 v119, v86, v87
  v_cvt_scalef32_pk_bf16_fp4 v167, v149, 1.0 op_sel:[1,1,0]
  v_mfma_f32_32x32x16_bf16 v[236:251], v[160:163], a[184:187], v[236:251]
  s_waitcnt lgkmcnt(5)
  ds_write_b128 v9, v[116:119] offset:19456
  v_cvt_scalef32_pk_bf16_fp4 v168, v142, 1.0 op_sel:[0,0,0]
  v_cvt_scalef32_pk_bf16_fp4 v169, v142, 1.0 op_sel:[1,0,0]
  v_cvt_scalef32_pk_bf16_fp4 v170, v142, 1.0 op_sel:[0,1,0]
  v_cvt_scalef32_pk_bf16_fp4 v171, v142, 1.0 op_sel:[1,1,0]
  v_mfma_f32_16x16x32_bf16 v[228:231], a[220:223], v[116:119], v[228:231]
  v_cvt_scalef32_pk_bf16_fp4 v172, v150, 1.0 op_sel:[0,0,0]
  v_cvt_scalef32_pk_bf16_fp4 v173, v150, 1.0 op_sel:[1,0,0]
  v_mfma_f32_32x32x16_bf16 v[236:251], v[164:167], a[188:191], v[236:251]
  s_waitcnt lgkmcnt(5)
  s_nop 3
  ds_write_b64 v14, v[228:229] offset:0
  ds_write_b64 v14, v[230:231] offset:512
  v_cvt_scalef32_pk_bf16_fp4 v174, v150, 1.0 op_sel:[0,1,0]
  v_cvt_scalef32_pk_bf16_fp4 v175, v150, 1.0 op_sel:[1,1,0]
  v_mfma_f32_32x32x16_bf16 v[236:251], v[168:171], a[192:195], v[236:251]
  s_waitcnt lgkmcnt(6)
  buffer_load_dwordx4 v[196:199], v17, s[24:27], s55 offen offset:0 sc1
  buffer_load_dwordx4 v[200:203], v17, s[24:27], s55 offen offset:1024 sc1
  buffer_load_dwordx4 v[204:207], v17, s[24:27], s55 offen offset:2048 sc1
  v_cvt_scalef32_pk_bf16_fp4 v176, v143, 1.0 op_sel:[0,0,0]
  v_cvt_scalef32_pk_bf16_fp4 v177, v143, 1.0 op_sel:[1,0,0]
  v_cvt_scalef32_pk_bf16_fp4 v178, v143, 1.0 op_sel:[0,1,0]
  v_cvt_scalef32_pk_bf16_fp4 v179, v143, 1.0 op_sel:[1,1,0]
  v_mfma_f32_32x32x16_bf16 v[236:251], v[172:175], a[196:199], v[236:251]
  s_waitcnt lgkmcnt(4)
  v_cvt_scalef32_pk_bf16_fp4 v152, v151, 1.0 op_sel:[0,0,0]
  v_cvt_scalef32_pk_bf16_fp4 v153, v151, 1.0 op_sel:[1,0,0]
  v_cvt_scalef32_pk_bf16_fp4 v154, v151, 1.0 op_sel:[0,1,0]
  v_cvt_scalef32_pk_bf16_fp4 v155, v151, 1.0 op_sel:[1,1,0]
  v_cvt_scalef32_pk_bf16_fp4 v156, v120, 1.0 op_sel:[0,0,0]
  v_cvt_scalef32_pk_bf16_fp4 v157, v120, 1.0 op_sel:[1,0,0]
  v_mfma_f32_32x32x16_bf16 v[236:251], v[176:179], a[200:203], v[236:251]
  s_waitcnt lgkmcnt(0)
  s_barrier
  ds_read_b128 v[56:59], v15 offset:9216
  ds_read_b128 v[60:63], v15 offset:9232
  ds_read_b128 a[160:163], v10 offset:16384
  v_cvt_scalef32_pk_bf16_fp4 v158, v120, 1.0 op_sel:[0,1,0]
  v_cvt_scalef32_pk_bf16_fp4 v159, v120, 1.0 op_sel:[1,1,0]
  v_mfma_f32_32x32x16_bf16 v[236:251], v[152:155], a[204:207], v[236:251]
  ds_read_b128 a[164:167], v10 offset:18432
  v_cvt_scalef32_pk_bf16_fp4 v160, v128, 1.0 op_sel:[0,0,0]
  v_cvt_scalef32_pk_bf16_fp4 v161, v128, 1.0 op_sel:[1,0,0]
  v_cvt_scalef32_pk_bf16_fp4 v162, v128, 1.0 op_sel:[0,1,0]
  v_cvt_scalef32_pk_bf16_fp4 v163, v128, 1.0 op_sel:[1,1,0]
  v_cvt_scalef32_pk_bf16_fp4 v164, v121, 1.0 op_sel:[0,0,0]
  v_mfma_f32_32x32x16_bf16 v[236:251], v[156:159], v[104:107], v[236:251]
  ds_read_b128 a[168:171], v10 offset:17408
  v_cvt_scalef32_pk_bf16_fp4 v165, v121, 1.0 op_sel:[1,0,0]
  v_cvt_scalef32_pk_bf16_fp4 v166, v121, 1.0 op_sel:[0,1,0]
L_hook2:
  s_cbranch_execz L_warmed
  v_cvt_scalef32_pk_bf16_fp4 v167, v121, 1.0 op_sel:[1,1,0]
  v_cvt_scalef32_pk_bf16_fp4 v168, v129, 1.0 op_sel:[0,0,0]
  v_cvt_scalef32_pk_bf16_fp4 v169, v129, 1.0 op_sel:[1,0,0]
  v_mfma_f32_32x32x16_bf16 v[236:251], v[160:163], v[112:115], v[236:251]
  ds_read_b128 a[172:175], v10 offset:19456
  v_cvt_scalef32_pk_bf16_fp4 v170, v129, 1.0 op_sel:[0,1,0]
  v_cvt_scalef32_pk_bf16_fp4 v171, v129, 1.0 op_sel:[1,1,0]
  v_cvt_scalef32_pk_bf16_fp4 v172, v122, 1.0 op_sel:[0,0,0]
  v_cvt_scalef32_pk_bf16_fp4 v173, v122, 1.0 op_sel:[1,0,0]
  v_cvt_scalef32_pk_bf16_fp4 v174, v122, 1.0 op_sel:[0,1,0]
  v_mfma_f32_32x32x16_bf16 v[236:251], v[164:167], v[108:111], v[236:251]
  ds_read_b128 a[176:179], v11 offset:16384
  v_cvt_scalef32_pk_bf16_fp4 v175, v122, 1.0 op_sel:[1,1,0]
  v_cvt_scalef32_pk_bf16_fp4 v176, v130, 1.0 op_sel:[0,0,0]
  v_cvt_scalef32_pk_bf16_fp4 v177, v130, 1.0 op_sel:[1,0,0]
  v_cvt_scalef32_pk_bf16_fp4 v178, v130, 1.0 op_sel:[0,1,0]
  v_cvt_scalef32_pk_bf16_fp4 v179, v130, 1.0 op_sel:[1,1,0]
  v_mfma_f32_32x32x16_bf16 v[236:251], v[168:171], v[116:119], v[236:251]
  s_waitcnt lgkmcnt(4)
  ds_read_b128 a[180:183], v11 offset:18432
  v_cvt_scalef32_pk_bf16_fp4 v152, v123, 1.0 op_sel:[0,0,0]
  v_cvt_scalef32_pk_bf16_fp4 v153, v123, 1.0 op_sel:[1,0,0]
  v_cvt_scalef32_pk_bf16_fp4 v154, v123, 1.0 op_sel:[0,1,0]
  v_cvt_scalef32_pk_bf16_fp4 v155, v123, 1.0 op_sel:[1,1,0]
  v_cvt_scalef32_pk_bf16_fp4 v156, v131, 1.0 op_sel:[0,0,0]
  v_mfma_f32_32x32x16_bf16 v[236:251], v[172:175], a[160:163], v[236:251]
  s_waitcnt lgkmcnt(4)
  ds_read_b128 a[184:187], v11 offset:17408
  v_cvt_scalef32_pk_bf16_fp4 v157, v131, 1.0 op_sel:[1,0,0]
  v_cvt_scalef32_pk_bf16_fp4 v158, v131, 1.0 op_sel:[0,1,0]
  v_cvt_scalef32_pk_bf16_fp4 v159, v131, 1.0 op_sel:[1,1,0]
  v_cvt_scalef32_pk_bf16_fp4 v160, v124, 1.0 op_sel:[0,0,0]
  v_cvt_scalef32_pk_bf16_fp4 v161, v124, 1.0 op_sel:[1,0,0]
  v_mfma_f32_32x32x16_bf16 v[236:251], v[176:179], a[164:167], v[236:251]
  s_waitcnt lgkmcnt(4)
  ds_read_b128 a[188:191], v11 offset:19456
  v_cvt_scalef32_pk_bf16_fp4 v162, v124, 1.0 op_sel:[0,1,0]
  v_cvt_scalef32_pk_bf16_fp4 v163, v124, 1.0 op_sel:[1,1,0]
  v_add_f32 v56, v56, v57
  v_add_f32 v58, v58, v59
  v_add_f32 v60, v60, v61
  v_mfma_f32_32x32x16_bf16 v[236:251], v[152:155], a[168:171], v[236:251]
  s_waitcnt vmcnt(6) lgkmcnt(4)
  ds_read_b128 a[192:195], v12 offset:16384
  v_cvt_scalef32_pk_bf16_fp4 v164, v132, 1.0 op_sel:[0,0,0]
  v_cvt_scalef32_pk_bf16_fp4 v165, v132, 1.0 op_sel:[1,0,0]
  v_cvt_scalef32_pk_bf16_fp4 v166, v132, 1.0 op_sel:[0,1,0]
  v_cvt_scalef32_pk_bf16_fp4 v167, v132, 1.0 op_sel:[1,1,0]
  v_cvt_scalef32_pk_bf16_fp4 v168, v125, 1.0 op_sel:[0,0,0]
  v_mfma_f32_32x32x16_bf16 v[236:251], v[156:159], a[172:175], v[236:251]
  s_waitcnt lgkmcnt(4)
  ds_read_b128 a[196:199], v12 offset:18432
  v_cvt_scalef32_pk_bf16_fp4 v169, v125, 1.0 op_sel:[1,0,0]
  v_cvt_scalef32_pk_bf16_fp4 v170, v125, 1.0 op_sel:[0,1,0]
  v_cvt_scalef32_pk_bf16_fp4 v171, v125, 1.0 op_sel:[1,1,0]
  v_cvt_scalef32_pk_bf16_fp4 v172, v133, 1.0 op_sel:[0,0,0]
  v_cvt_scalef32_pk_bf16_fp4 v173, v133, 1.0 op_sel:[1,0,0]
  v_mfma_f32_32x32x16_bf16 v[236:251], v[160:163], a[176:179], v[236:251]
  s_waitcnt lgkmcnt(4)
  ds_read_b128 a[200:203], v12 offset:17408
  ds_read_b128 v[180:183], v9 offset:49152
  ds_read_b128 v[184:187], v9 offset:50176
  v_cvt_scalef32_pk_bf16_fp4 v174, v133, 1.0 op_sel:[0,1,0]
  v_cvt_scalef32_pk_bf16_fp4 v175, v133, 1.0 op_sel:[1,1,0]
  v_cvt_scalef32_pk_bf16_fp4 v176, v126, 1.0 op_sel:[0,0,0]
  v_mfma_f32_32x32x16_bf16 v[236:251], v[164:167], a[180:183], v[236:251]
  s_waitcnt lgkmcnt(6)
  ds_read_b128 a[204:207], v12 offset:19456
  v_cvt_scalef32_pk_bf16_fp4 v177, v126, 1.0 op_sel:[1,0,0]
  v_cvt_scalef32_pk_bf16_fp4 v178, v126, 1.0 op_sel:[0,1,0]
  v_cvt_scalef32_pk_bf16_fp4 v179, v126, 1.0 op_sel:[1,1,0]
  v_cvt_scalef32_pk_bf16_fp4 v152, v134, 1.0 op_sel:[0,0,0]
  v_cvt_scalef32_pk_bf16_fp4 v153, v134, 1.0 op_sel:[1,0,0]
  v_mfma_f32_32x32x16_bf16 v[236:251], v[168:171], a[184:187], v[236:251]
  s_waitcnt lgkmcnt(6)
  v_cvt_scalef32_pk_bf16_fp4 v154, v134, 1.0 op_sel:[0,1,0]
  v_cvt_scalef32_pk_bf16_fp4 v155, v134, 1.0 op_sel:[1,1,0]
  v_cvt_scalef32_pk_bf16_fp4 v156, v127, 1.0 op_sel:[0,0,0]
  v_cvt_scalef32_pk_bf16_fp4 v157, v127, 1.0 op_sel:[1,0,0]
  v_cvt_scalef32_pk_bf16_fp4 v158, v127, 1.0 op_sel:[0,1,0]
  v_cvt_scalef32_pk_bf16_fp4 v159, v127, 1.0 op_sel:[1,1,0]
  v_mfma_f32_32x32x16_bf16 v[236:251], v[172:175], a[188:191], v[236:251]
  s_waitcnt lgkmcnt(5)
  v_cvt_scalef32_pk_bf16_fp4 v160, v135, 1.0 op_sel:[0,0,0]
  v_cvt_scalef32_pk_bf16_fp4 v161, v135, 1.0 op_sel:[1,0,0]
  v_cvt_scalef32_pk_bf16_fp4 v162, v135, 1.0 op_sel:[0,1,0]
  v_cvt_scalef32_pk_bf16_fp4 v163, v135, 1.0 op_sel:[1,1,0]
  v_add_f32 v62, v62, v63
  v_add_f32 v56, v56, v58
  v_mfma_f32_32x32x16_bf16 v[236:251], v[176:179], a[192:195], v[236:251]
  s_waitcnt lgkmcnt(4)
  v_add_f32 v60, v60, v62
  v_add_f32 v20, v56, v60
  v_mfma_f32_32x32x16_bf16 v[236:251], v[152:155], a[196:199], v[236:251]
  s_waitcnt lgkmcnt(3)
  v_mfma_f32_32x32x16_bf16 v[236:251], v[156:159], a[200:203], v[236:251]
  s_waitcnt vmcnt(0) lgkmcnt(0)
  v_cmp_eq_u32 vcc, s61, v199
  v_cmp_eq_u32 s[52:53], s61, v203
  v_cmp_eq_u32 s[20:21], s61, v207
  s_and_b64 vcc, vcc, s[52:53]
  s_and_b64 vcc, vcc, s[20:21]
  s_cmp_eq_u64 vcc, -1
  s_cbranch_scc0 L_xspin0
L_xok:
  v_mfma_f32_32x32x16_bf16 v[236:251], v[160:163], a[204:207], v[236:251]
  v_mov_b32 v199, v204
  v_mov_b32 v203, v205
  v_add_f32 v20, v20, v206
  v_mfma_f32_32x32x16_bf16 v[236:251], v[180:183], v[196:199], v[236:251]
  v_rcp_f32 v22, v20
  v_cmp_lt_f32 vcc, 0x26800000, v20
  v_cmp_gt_f32 s[52:53], s19, v20
  v_mfma_f32_32x32x16_bf16 v[236:251], v[184:187], v[200:203], v[236:251]
  s_and_b64 vcc, vcc, s[52:53]
  s_cmp_eq_u64 vcc, -1
  s_cbranch_scc0 L_slow
  s_add_u32 s38, s56, 4096
L_pack:
  s_nop 7
  v_mul_f32 v180, v236, v22
  v_mul_f32 v184, v240, v22
  v_mul_f32 v188, v244, v22
  v_mul_f32 v192, v248, v22
  v_cvt_pk_bf16_f32 v88, v180, v184
  v_cvt_pk_bf16_f32 v89, v188, v192
  v_mul_f32 v181, v237, v22
  v_mul_f32 v185, v241, v22
  v_mul_f32 v189, v245, v22
  v_mul_f32 v193, v249, v22
  v_cvt_pk_bf16_f32 v90, v181, v185
  v_cvt_pk_bf16_f32 v91, v189, v193
  ds_write_b128 v7, v[88:91] offset:11264
  v_mul_f32 v182, v238, v22
  v_mul_f32 v186, v242, v22
  v_mul_f32 v190, v246, v22
  v_mul_f32 v194, v250, v22
  v_cvt_pk_bf16_f32 v92, v182, v186
  v_cvt_pk_bf16_f32 v93, v190, v194
  v_mul_f32 v183, v239, v22
  v_mul_f32 v187, v243, v22
  v_mul_f32 v191, v247, v22
  v_mul_f32 v195, v251, v22
  v_cvt_pk_bf16_f32 v94, v183, v187
  v_cvt_pk_bf16_f32 v95, v191, v195
  ds_write_b128 v7, v[92:95] offset:11280
  ds_read_b128 v[96:99], v8 offset:11264
  ds_read_b128 v[100:103], v8 offset:12544
  s_waitcnt lgkmcnt(1)
  buffer_store_dwordx4 v[96:99], v16, s[28:31], s56 offen
  s_waitcnt lgkmcnt(0)
  buffer_store_dwordx4 v[100:103], v16, s[28:31], s38 offen

  s_and_b32 s52, s57, 63
  s_cbranch_scc1 L_nobump
  s_add_u32 s52, s39, 1
  s_lshl_b32 s53, s33, 7
  v_mov_b32 v22, s52
  buffer_store_dword v22, v19, s[24:27], s53 offen

L_nobump:
L_end:
  s_endpgm
L_pollA_more:
  buffer_load_dword v26, v237, s[24:27], s59 offen sc1
  s_add_u32 s19, s19, 1
  s_cmp_lt_u32 s19, 64
  s_cbranch_scc1 L_pollA
  s_waitcnt vmcnt(0)

  v_lshlrev_b32 v27, 4, v237
  s_lshl_b32 s52, s34, 11
  v_add_u32 v27, s52, v27
  s_mov_b32 s53, 0

L_pollB0:
  buffer_load_dword v26, v27, s[24:27], s60 offen sc1
  s_add_u32 s53, s53, 1
  s_waitcnt vmcnt(0)
  v_cmp_eq_u32 vcc, s61, v26
  s_cmp_eq_u64 vcc, -1
  s_cbranch_scc1 L_pollB0_ok
  s_sleep 4
  s_cmp_lt_u32 s53, 0x100000
  s_cbranch_scc1 L_pollB0

L_pollB0_ok:
  s_branch L_go
L_bspin0:
  s_mov_b32 s53, 0
L_bspin:
  buffer_load_dword v22, v20, s[24:27], s60 offen sc1
  s_add_u32 s53, s53, 1
  s_waitcnt vmcnt(0)
  v_cmp_eq_u32 vcc, s61, v22
  s_cmp_eq_u64 vcc, -1
  s_cbranch_scc1 L_bok
  s_cmp_lt_u32 s53, 0x100000
  s_cbranch_scc1 L_bspin
  s_branch L_bok

L_xspin0:
  s_mov_b32 s38, 0
L_xspin:
  buffer_load_dwordx4 v[196:199], v17, s[24:27], s55 offen offset:0 sc1
  buffer_load_dwordx4 v[200:203], v17, s[24:27], s55 offen offset:1024 sc1
  buffer_load_dwordx4 v[204:207], v17, s[24:27], s55 offen offset:2048 sc1
  s_add_u32 s38, s38, 1
  s_waitcnt vmcnt(0)
  v_cmp_eq_u32 vcc, s61, v199
  v_cmp_eq_u32 s[52:53], s61, v203
  v_cmp_eq_u32 s[20:21], s61, v207
  s_and_b64 vcc, vcc, s[52:53]
  s_and_b64 vcc, vcc, s[20:21]
  s_cmp_eq_u64 vcc, -1
  s_cbranch_scc1 L_xok
  s_cmp_lt_u32 s38, 0x100000
  s_cbranch_scc1 L_xspin
  s_branch L_xok
L_slow:
  s_waitcnt vmcnt(0) lgkmcnt(0)
  s_mul_i32 s40, s33, 655360
  s_add_u32 s40, s40, 4194304
  v_add_u32 v4, 0x1000, v17
  v_mov_b32 v40, 0xff800000
  s_mov_b32 s41, s40
  s_mov_b32 s42, 0

L_slow1:
  buffer_load_dwordx4 a[64:67], v17, s[24:27], s41 offen offset:0 sc1
  buffer_load_dwordx4 a[68:71], v17, s[24:27], s41 offen offset:1024 sc1
  buffer_load_dwordx4 a[72:75], v17, s[24:27], s41 offen offset:2048 sc1
  buffer_load_dwordx4 a[76:79], v17, s[24:27], s41 offen offset:3072 sc1
  buffer_load_dwordx4 a[80:83], v4, s[24:27], s41 offen offset:0 sc1
  buffer_load_dwordx4 a[84:87], v4, s[24:27], s41 offen offset:1024 sc1
  buffer_load_dwordx4 a[88:91], v4, s[24:27], s41 offen offset:2048 sc1
  buffer_load_dwordx4 a[92:95], v4, s[24:27], s41 offen offset:3072 sc1
  s_waitcnt vmcnt(0)
  v_mfma_f32_32x32x16_bf16 v[24:39], a[64:67], a[0:3], 0
  v_mfma_f32_32x32x16_bf16 v[24:39], a[68:71], a[4:7], v[24:39]
  v_mfma_f32_32x32x16_bf16 v[24:39], a[72:75], a[8:11], v[24:39]
  v_mfma_f32_32x32x16_bf16 v[24:39], a[76:79], a[12:15], v[24:39]
  v_mfma_f32_32x32x16_bf16 v[24:39], a[80:83], a[16:19], v[24:39]
  v_mfma_f32_32x32x16_bf16 v[24:39], a[84:87], a[20:23], v[24:39]
  v_mfma_f32_32x32x16_bf16 v[24:39], a[88:91], a[24:27], v[24:39]
  v_mfma_f32_32x32x16_bf16 v[24:39], a[92:95], a[28:31], v[24:39]
  s_nop 15
  v_max3_f32 v40, v24, v25, v40
  v_max3_f32 v40, v26, v27, v40
  v_max3_f32 v40, v28, v29, v40
  v_max3_f32 v40, v30, v31, v40
  v_max3_f32 v40, v32, v33, v40
  v_max3_f32 v40, v34, v35, v40
  v_max3_f32 v40, v36, v37, v40
  v_max3_f32 v40, v38, v39, v40
  s_add_u32 s41, s41, 10240
  s_add_u32 s42, s42, 1
  s_cmp_lt_u32 s42, 64
  s_cbranch_scc1 L_slow1
  v_mov_b32 v41, v40
  s_nop 1
  v_permlane32_swap_b32 v40, v41
  v_max_f32 v40, v40, v41
  v_mov_b32 v42, 0
  v_and_b32 v43, 7, v2
  v_bfe_u32 v44, v2, 3, 2
  v_lshl_add_u32 v43, v43, 2, v44
  v_lshl_add_u32 v43, v1, 5, v43
  v_lshlrev_b32 v43, 2, v43
  v_lshrrev_b32 v44, 5, v2
  s_lshl_b32 s52, s33, 11
  v_lshl_add_u32 v44, v44, 2, s52
  v_lshl_add_u32 v43, v44, 9, v43
  v_lshlrev_b32 v44, 1, v44
  s_mov_b32 s41, s40
  s_mov_b32 s42, 0

  v_mov_b32 v236, 0
  v_mov_b32 v237, 0
  v_mov_b32 v238, 0
  v_mov_b32 v239, 0
  v_mov_b32 v240, 0
  v_mov_b32 v241, 0
  v_mov_b32 v242, 0
  v_mov_b32 v243, 0
  v_mov_b32 v244, 0
  v_mov_b32 v245, 0
  v_mov_b32 v246, 0
  v_mov_b32 v247, 0
  v_mov_b32 v248, 0
  v_mov_b32 v249, 0
  v_mov_b32 v250, 0
  v_mov_b32 v251, 0
L_slow2:
  global_load_dwordx2 v[64:65], v44, s[14:15] offset:0
  global_load_dwordx2 v[72:73], v44, s[16:17] offset:0
  global_load_dword v48, v43, s[12:13] offset:0
  global_load_dword v49, v43, s[12:13] offset:512
  global_load_dword v50, v43, s[12:13] offset:1024
  global_load_dword v51, v43, s[12:13] offset:1536
  v_add_u32 v43, 0x1000, v43
  global_load_dwordx2 v[66:67], v44, s[14:15] offset:16
  global_load_dwordx2 v[74:75], v44, s[16:17] offset:16
  global_load_dword v52, v43, s[12:13] offset:0
  global_load_dword v53, v43, s[12:13] offset:512
  global_load_dword v54, v43, s[12:13] offset:1024
  global_load_dword v55, v43, s[12:13] offset:1536
  v_add_u32 v43, 0x1000, v43
  global_load_dwordx2 v[68:69], v44, s[14:15] offset:32
  global_load_dwordx2 v[76:77], v44, s[16:17] offset:32
  global_load_dword v56, v43, s[12:13] offset:0
  global_load_dword v57, v43, s[12:13] offset:512
  global_load_dword v58, v43, s[12:13] offset:1024
  global_load_dword v59, v43, s[12:13] offset:1536
  v_add_u32 v43, 0x1000, v43
  global_load_dwordx2 v[70:71], v44, s[14:15] offset:48
  global_load_dwordx2 v[78:79], v44, s[16:17] offset:48
  global_load_dword v60, v43, s[12:13] offset:0
  global_load_dword v61, v43, s[12:13] offset:512
  global_load_dword v62, v43, s[12:13] offset:1024
  global_load_dword v63, v43, s[12:13] offset:1536
  v_add_u32 v43, 0x1000, v43
  v_add_u32 v44, 64, v44
  buffer_load_dwordx4 a[64:67], v17, s[24:27], s41 offen offset:0 sc1
  buffer_load_dwordx4 a[68:71], v17, s[24:27], s41 offen offset:1024 sc1
  buffer_load_dwordx4 a[72:75], v17, s[24:27], s41 offen offset:2048 sc1
  buffer_load_dwordx4 a[76:79], v17, s[24:27], s41 offen offset:3072 sc1
  buffer_load_dwordx4 a[80:83], v4, s[24:27], s41 offen offset:0 sc1
  buffer_load_dwordx4 a[84:87], v4, s[24:27], s41 offen offset:1024 sc1
  buffer_load_dwordx4 a[88:91], v4, s[24:27], s41 offen offset:2048 sc1
  buffer_load_dwordx4 a[92:95], v4, s[24:27], s41 offen offset:3072 sc1
  s_waitcnt vmcnt(0)
  v_mfma_f32_32x32x16_bf16 v[24:39], a[64:67], a[0:3], 0
  v_mfma_f32_32x32x16_bf16 v[24:39], a[68:71], a[4:7], v[24:39]
  v_mfma_f32_32x32x16_bf16 v[24:39], a[72:75], a[8:11], v[24:39]
  v_mfma_f32_32x32x16_bf16 v[24:39], a[76:79], a[12:15], v[24:39]
  v_mfma_f32_32x32x16_bf16 v[24:39], a[80:83], a[16:19], v[24:39]
  v_mfma_f32_32x32x16_bf16 v[24:39], a[84:87], a[20:23], v[24:39]
  v_mfma_f32_32x32x16_bf16 v[24:39], a[88:91], a[24:27], v[24:39]
  v_mfma_f32_32x32x16_bf16 v[24:39], a[92:95], a[28:31], v[24:39]
  s_nop 15
  v_sub_f32 v24, v24, v40
  v_sub_f32 v25, v25, v40
  v_sub_f32 v26, v26, v40
  v_sub_f32 v27, v27, v40
  v_sub_f32 v28, v28, v40
  v_sub_f32 v29, v29, v40
  v_sub_f32 v30, v30, v40
  v_sub_f32 v31, v31, v40
  v_sub_f32 v32, v32, v40
  v_sub_f32 v33, v33, v40
  v_sub_f32 v34, v34, v40
  v_sub_f32 v35, v35, v40
  v_sub_f32 v36, v36, v40
  v_sub_f32 v37, v37, v40
  v_sub_f32 v38, v38, v40
  v_sub_f32 v39, v39, v40
  v_exp_f32 v24, v24
  v_exp_f32 v25, v25
  v_exp_f32 v26, v26
  v_exp_f32 v27, v27
  v_exp_f32 v28, v28
  v_exp_f32 v29, v29
  v_exp_f32 v30, v30
  v_exp_f32 v31, v31
  v_exp_f32 v32, v32
  v_exp_f32 v33, v33
  v_exp_f32 v34, v34
  v_exp_f32 v35, v35
  v_exp_f32 v36, v36
  v_exp_f32 v37, v37
  v_exp_f32 v38, v38
  v_exp_f32 v39, v39
  v_add_f32 v42, v42, v24
  v_add_f32 v42, v42, v25
  v_add_f32 v42, v42, v26
  v_add_f32 v42, v42, v27
  v_add_f32 v42, v42, v28
  v_add_f32 v42, v42, v29
  v_add_f32 v42, v42, v30
  v_add_f32 v42, v42, v31
  v_add_f32 v42, v42, v32
  v_add_f32 v42, v42, v33
  v_add_f32 v42, v42, v34
  v_add_f32 v42, v42, v35
  v_add_f32 v42, v42, v36
  v_add_f32 v42, v42, v37
  v_add_f32 v42, v42, v38
  v_add_f32 v42, v42, v39
  v_cvt_pk_bf16_f32 v80, v24, v25
  v_cvt_pk_bf16_f32 v81, v26, v27
  v_cvt_pk_bf16_f32 v82, v28, v29
  v_cvt_pk_bf16_f32 v83, v30, v31
  v_cvt_pk_bf16_f32 v84, v32, v33
  v_cvt_pk_bf16_f32 v85, v34, v35
  v_cvt_pk_bf16_f32 v86, v36, v37
  v_cvt_pk_bf16_f32 v87, v38, v39
  v_cvt_f32_i32 v48, v48
  v_cvt_f32_i32 v49, v49
  v_lshlrev_b32 v45, 16, v72
  v_and_b32 v46, 0xffff0000, v72
  v_sub_f32 v48, v48, v45
  v_sub_f32 v49, v49, v46
  v_lshlrev_b32 v45, 16, v64
  v_and_b32 v46, 0xffff0000, v64
  v_mul_f32 v48, v48, v45
  v_mul_f32 v49, v49, v46
  v_cvt_pk_bf16_f32 v88, v48, v49

  v_cvt_f32_i32 v50, v50
  v_cvt_f32_i32 v51, v51
  v_lshlrev_b32 v45, 16, v73
  v_and_b32 v46, 0xffff0000, v73
  v_sub_f32 v50, v50, v45
  v_sub_f32 v51, v51, v46
  v_lshlrev_b32 v45, 16, v65
  v_and_b32 v46, 0xffff0000, v65
  v_mul_f32 v50, v50, v45
  v_mul_f32 v51, v51, v46
  v_cvt_pk_bf16_f32 v89, v50, v51

  v_cvt_f32_i32 v52, v52
  v_cvt_f32_i32 v53, v53
  v_lshlrev_b32 v45, 16, v74
  v_and_b32 v46, 0xffff0000, v74
  v_sub_f32 v52, v52, v45
  v_sub_f32 v53, v53, v46
  v_lshlrev_b32 v45, 16, v66
  v_and_b32 v46, 0xffff0000, v66
  v_mul_f32 v52, v52, v45
  v_mul_f32 v53, v53, v46
  v_cvt_pk_bf16_f32 v90, v52, v53

  v_cvt_f32_i32 v54, v54
  v_cvt_f32_i32 v55, v55
  v_lshlrev_b32 v45, 16, v75
  v_and_b32 v46, 0xffff0000, v75
  v_sub_f32 v54, v54, v45
  v_sub_f32 v55, v55, v46
  v_lshlrev_b32 v45, 16, v67
  v_and_b32 v46, 0xffff0000, v67
  v_mul_f32 v54, v54, v45
  v_mul_f32 v55, v55, v46
  v_cvt_pk_bf16_f32 v91, v54, v55

  v_cvt_f32_i32 v56, v56
  v_cvt_f32_i32 v57, v57
  v_lshlrev_b32 v45, 16, v76
  v_and_b32 v46, 0xffff0000, v76
  v_sub_f32 v56, v56, v45
  v_sub_f32 v57, v57, v46
  v_lshlrev_b32 v45, 16, v68
  v_and_b32 v46, 0xffff0000, v68
  v_mul_f32 v56, v56, v45
  v_mul_f32 v57, v57, v46
  v_cvt_pk_bf16_f32 v92, v56, v57

  v_cvt_f32_i32 v58, v58
  v_cvt_f32_i32 v59, v59
  v_lshlrev_b32 v45, 16, v77
  v_and_b32 v46, 0xffff0000, v77
  v_sub_f32 v58, v58, v45
  v_sub_f32 v59, v59, v46
  v_lshlrev_b32 v45, 16, v69
  v_and_b32 v46, 0xffff0000, v69
  v_mul_f32 v58, v58, v45
  v_mul_f32 v59, v59, v46
  v_cvt_pk_bf16_f32 v93, v58, v59

  v_cvt_f32_i32 v60, v60
  v_cvt_f32_i32 v61, v61
  v_lshlrev_b32 v45, 16, v78
  v_and_b32 v46, 0xffff0000, v78
  v_sub_f32 v60, v60, v45
  v_sub_f32 v61, v61, v46
  v_lshlrev_b32 v45, 16, v70
  v_and_b32 v46, 0xffff0000, v70
  v_mul_f32 v60, v60, v45
  v_mul_f32 v61, v61, v46
  v_cvt_pk_bf16_f32 v94, v60, v61

  v_cvt_f32_i32 v62, v62
  v_cvt_f32_i32 v63, v63
  v_lshlrev_b32 v45, 16, v79
  v_and_b32 v46, 0xffff0000, v79
  v_sub_f32 v62, v62, v45
  v_sub_f32 v63, v63, v46
  v_lshlrev_b32 v45, 16, v71
  v_and_b32 v46, 0xffff0000, v71
  v_mul_f32 v62, v62, v45
  v_mul_f32 v63, v63, v46
  v_cvt_pk_bf16_f32 v95, v62, v63

  s_nop 1
  v_mfma_f32_32x32x16_bf16 v[236:251], v[88:91], v[80:83], v[236:251]
  v_mfma_f32_32x32x16_bf16 v[236:251], v[92:95], v[84:87], v[236:251]
  s_add_u32 s41, s41, 10240
  s_add_u32 s42, s42, 1
  s_cmp_lt_u32 s42, 64
  s_cbranch_scc1 L_slow2
  v_mov_b32 v41, v42
  s_nop 15
  v_permlane32_swap_b32 v42, v41
  v_add_f32 v42, v42, v41
  v_rcp_f32 v22, v42
  s_add_u32 s38, s56, 4096
  s_branch L_pack

.fill 2048, 4, 0xBF800000
L_textend:
.if (L_textend - standalone__kv_cache_quant_pre_rope_vs_post_rope__prompt_kernel) < 24704
.error "code prefetch would run past the end of the section"
.endif
.section .rodata,"a"
.p2align 6
.amdhsa_kernel standalone__kv_cache_quant_pre_rope_vs_post_rope__prompt_kernel
  .amdhsa_next_free_vgpr 512
  .amdhsa_next_free_sgpr 102
  .amdhsa_accum_offset 256
  .amdhsa_group_segment_fixed_size 0
  .amdhsa_kernarg_size 112
  .amdhsa_user_sgpr_count 2
  .amdhsa_user_sgpr_kernarg_segment_ptr 1
  .amdhsa_system_sgpr_workgroup_id_x 1
  .amdhsa_float_denorm_mode_32 3
  .amdhsa_float_denorm_mode_16_64 3
  .amdhsa_ieee_mode 0
  .amdhsa_dx10_clamp 0
.end_amdhsa_kernel
```
